```python
import torch

def _softmax(x, axis=-1):
    return torch.softmax(x, dim=axis)

def _gelu(x):
    return torch.nn.functional.gelu(x, approximate='tanh')

def _silu(x):
    return torch.nn.functional.silu(x)

def _sigmoid(x):
    return torch.sigmoid(x)

def _layernorm(x, axis=-1, eps=1e-05):
    m = x.mean(dim=axis, keepdim=True)
    v = x.var(dim=axis, keepdim=True, unbiased=False)
    return (x - m) / torch.sqrt(v + eps)

def _scatter_add(tgt, idx, src, axis=0):
    return tgt.clone().index_add_(axis, idx, src)

def _segment_sum(src, seg, n):
    out = torch.zeros((n,) + src.shape[1:], dtype=src.dtype)
    return out.index_add_(0, seg, src)

def _pad(x, pw):
    flat = tuple((v for pair in reversed(pw) for v in pair))
    return torch.nn.functional.pad(x, flat)
kernel_name = 'adaLN_cond__ssm_conv_s4d__moe_arch_mod__prompt'

def setup_inputs():

    _w = lambda a: (lambda t: t.to(torch.bfloat16) if t.is_floating_point() else t)(torch.as_tensor(a))

    def _A_setup():
        Bsz, L, D, N = (1, 2048, 512, 128)
        return {'u': _w((lambda *s: torch.randn(*s, dtype=torch.bfloat16) * 0.05)(Bsz, L, D)), 'log_A_real': _w((lambda *s: torch.randn(*s, dtype=torch.bfloat16) * 3.2)(D, N) * 0.5), 'A_imag': _w((lambda *s: torch.randn(*s, dtype=torch.bfloat16) * 0.1)(D, N) * 3.14), 'C_real': _w((lambda *s: torch.randn(*s, dtype=torch.bfloat16) * 0.4)(D, N) / N ** 0.5), 'C_imag': _w((lambda *s: torch.randn(*s, dtype=torch.bfloat16) * 0.4)(D, N) / N ** 0.5), 'log_dt': _w((lambda *s: torch.randn(*s, dtype=torch.bfloat16) * 0.1)(D) * 0.5 - 4.0), 'D_skip': _w((lambda *s: torch.randn(*s, dtype=torch.bfloat16) * 0.1)(D))}
    _A_in = _A_setup()

    def _B_setup():
        B, S, D, F, C = (1, 2048, 512, 1376, 2)
        return {'x': _w((lambda *s: torch.randn(*s, dtype=torch.bfloat16) * 0.05)(B, S, D)), 'w_r': _w((lambda *s: torch.randn(*s, dtype=torch.bfloat16) * 0.05)(D)), 'w_gate': _w((lambda *s: torch.randn(*s, dtype=torch.bfloat16) * 0.05)(D, F)), 'w_up': _w((lambda *s: torch.randn(*s, dtype=torch.bfloat16) * 0.05)(D, F)), 'w_down': _w((lambda *s: torch.randn(*s, dtype=torch.bfloat16) * 0.05)(F, D))}
    _B_in = _B_setup()
    return {'A_u': _A_in['u'], 'A_log_A_real': _A_in['log_A_real'], 'A_A_imag': _A_in['A_imag'], 'A_C_real': _A_in['C_real'], 'A_C_imag': _A_in['C_imag'], 'A_log_dt': _A_in['log_dt'], 'A_D_skip': _A_in['D_skip'], 'B_x': _B_in['x'], 'B_w_r': _B_in['w_r'], 'B_w_gate': _B_in['w_gate'], 'B_w_up': _B_in['w_up'], 'B_w_down': _B_in['w_down'], 'c': _w((lambda *s: torch.randn(*s, dtype=torch.bfloat16) * 0.1)(1, 512) * 8.0), 'w_mod': _w((lambda *s: torch.randn(*s, dtype=torch.bfloat16) * 0.1)(512, 6 * 512) * 512 ** (-0.5) * 8.0)}

def reference(A_u, A_log_A_real, A_A_imag, A_C_real, A_C_imag, A_log_dt, A_D_skip, B_x, B_w_r, B_w_gate, B_w_up, B_w_down, c, w_mod):

    def _A_ref(u, log_A_real, A_imag, C_real, C_imag, log_dt, D_skip):
        L = u.shape[1]
        dt = torch.exp(log_dt)
        A = -torch.exp(log_A_real) + 1j * A_imag
        C = (C_real + 1j * C_imag) * dt[:, None]
        pos = (lambda x, dt: x.to(dt))(torch.arange(L), log_dt.dtype)
        P = torch.exp((A * dt[:, None])[:, :, None] * pos[None, None, :])
        K = 2.0 * torch.einsum('dn,dnl->dl', C, P).real
        L2 = 2 * L
        u_t = (lambda x, *d: x.permute(*d))(u, 0, 2, 1)
        Kf = (lambda x, *a, **k: torch.fft.rfft(x.float(), *a, **k))(K, L2)
        Uf = (lambda x, *a, **k: torch.fft.rfft(x.float(), *a, **k))(u_t, L2)
        y = (lambda x, *a, **k: torch.fft.irfft(x, *a, **k).to(torch.bfloat16))(Uf * Kf[None, :, :], L2)[:, :, :L]
        y = (lambda x, *d: x.permute(*d))(y, 0, 2, 1)
        return y + u * D_skip[None, None, :]

    def _B_ref(x, w_r, w_gate, w_up, w_down):
        B, S, D = x.shape
        C = 2
        r = x @ w_r
        idx = torch.argsort(-r, axis=-1)[:, :C]
        idx_e = (lambda x, n, axis: torch.repeat_interleave(x, n, dim=axis))(idx.reshape(B, C, 1), D, axis=2)
        x_sel = (lambda x, i, axis: torch.take_along_dim(x, i, dim=axis))(x, idx_e, axis=1)
        g = _silu(x_sel @ w_gate)
        u = x_sel @ w_up
        y = g * u @ w_down
        r_sel = _sigmoid((lambda x, i, axis: torch.take_along_dim(x, i, dim=axis))(r, idx, axis=1))
        y = y * r_sel.reshape(B, C, 1)
        b_off = (torch.arange(B) * S).reshape(B, 1)
        flat_idx = (idx + b_off).reshape(B * C)
        zero = (x * 0.0).reshape(B * S, D)
        upd = _scatter_add(zero, flat_idx, y.reshape(B * C, D), axis=0)
        return x + upd.reshape(B, S, D)
    x = A_u
    mod = (_silu(c) @ w_mod).reshape(c.shape[0], 6, 1, -1)
    sa, ca, ga, sb, cb, gb = (mod[:, 0].clone(), mod[:, 1].clone(), mod[:, 2].clone(), mod[:, 3].clone(), mod[:, 4].clone(), mod[:, 5].clone())
    h = _layernorm(x, axis=-1) * (1 + ca) + sa
    x = x + ga * _A_ref(h, A_log_A_real, A_A_imag, A_C_real, A_C_imag, A_log_dt, A_D_skip)
    h = _layernorm(x, axis=-1) * (1 + cb) + sb
    x = x + gb * _B_ref(h, B_w_r, B_w_gate, B_w_up, B_w_down)
    return x
```

```asm
; @launch grid=(256,1,1) block=(512,1,1) lds=142144
.amdgcn_target "amdgcn-amd-amdhsa--gfx950"
.text
.globl adaLN_cond__ssm_conv_s4d__moe_arch_mod__prompt_kernel
.p2align 8
.type adaLN_cond__ssm_conv_s4d__moe_arch_mod__prompt_kernel,@function
adaLN_cond__ssm_conv_s4d__moe_arch_mod__prompt_kernel:
    s_cmp_ge_u32 s2, 256
    s_cbranch_scc1 L_exit
    s_load_dwordx16 s[4:19], s[0:1], 0
    s_load_dwordx16 s[20:35], s[0:1], 64
    s_load_dwordx2 s[36:37], s[0:1], 128
    v_and_b32 v1, 63, v0
    v_lshrrev_b32 v2, 6, v0
    s_and_b32 s38, s2, 7
    s_lshl_b32 s38, s38, 5
    s_lshr_b32 s3, s2, 3
    s_add_u32 s38, s38, s3
    v_readfirstlane_b32 s39, v2
    s_mov_b32 s44, 0xffff0000
    s_lshl_b32 s50, s38, 2
    s_lshl_b32 s3, s38, 3
    s_add_u32 s3, s3, s39
    s_lshl_b32 s51, s3, 10
    v_lshlrev_b32 v2, 4, v1
    v_add_u32 v3, s51, v2
    s_cmp_lt_u32 s39, 4
    s_cbranch_scc0 L_pro_helper
    s_lshl_b32 s52, s38, 9
    s_lshl_b32 s53, s39, 7
    s_add_u32 s52, s52, s53
    v_lshlrev_b32 v16, 1, v1
    v_add_u32 v16, s52, v16
    s_waitcnt lgkmcnt(0)
    v_mov_b32 v44, 0
    v_lshlrev_b32 v17, 2, v1
    v_add_u32 v17, 86848, v17
    ds_write_b32 v17, v44
    global_load_ushort v12, v16, s[6:7]
    global_load_ushort v13, v16, s[8:9]
    global_load_ushort v14, v16, s[10:11]
    global_load_ushort v15, v16, s[12:13]
    s_lshr_b32 s53, s39, 1
    s_lshl_b32 s53, s53, 1
    s_add_u32 s53, s53, s50
    v_mov_b32 v19, s53
    global_load_ushort v19, v19, s[14:15]
    global_load_dwordx4 v[4:7], v3, s[4:5]
    s_waitcnt lgkmcnt(0)
    s_load_dword s41, s[36:37], 0
    s_load_dword s43, s[16:17], s50
    s_barrier
    v_and_b32 v44, 255, v0
    v_lshlrev_b32 v45, 3, v44
    v_sub_u32 v45, 2048, v45
    v_cvt_f32_u32 v64, v45
    s_lshr_b32 s60, s39, 2
    s_lshl_b32 s61, s60, 11
    s_add_u32 s61, s61, 65600
    s_sub_u32 s62, s61, 0x8500
    v_mov_b32 v47, s62
    v_add_f32 v65, -1.0, v64
    v_add_f32 v66, -1.0, v65
    v_add_f32 v67, -1.0, v66
    v_add_f32 v68, -1.0, v67
    v_add_f32 v69, -1.0, v68
    v_add_f32 v70, -1.0, v69
    v_add_f32 v71, -1.0, v70
    v_add_f32 v72, -1.0, v71
    v_cvt_pk_bf16_f32 v84, v64, v65
    v_cvt_pk_bf16_f32 v85, v66, v67
    v_cvt_pk_bf16_f32 v86, v68, v69
    v_cvt_pk_bf16_f32 v87, v70, v71
    v_cvt_pk_bf16_f32 v88, v72, v72
    v_mad_u32_u16 v238, v84, 2, v47 op_sel:[0,0,0,0]
    v_mad_u32_u16 v239, v84, 2, v47 op_sel:[1,0,0,0]
    v_mad_u32_u16 v240, v85, 2, v47 op_sel:[0,0,0,0]
    v_mad_u32_u16 v241, v85, 2, v47 op_sel:[1,0,0,0]
    v_mad_u32_u16 v242, v86, 2, v47 op_sel:[0,0,0,0]
    v_mad_u32_u16 v243, v86, 2, v47 op_sel:[1,0,0,0]
    v_mad_u32_u16 v244, v87, 2, v47 op_sel:[0,0,0,0]
    v_mad_u32_u16 v245, v87, 2, v47 op_sel:[1,0,0,0]
    v_mad_u32_u16 v246, v88, 2, v47 op_sel:[0,0,0,0]
    s_and_b32 s62, s39, 3
    s_cmp_eq_u32 s62, 3
    s_cbranch_scc0 L_nofix_1
    v_lshl_add_u32 v45, v45, 1, s61
    s_add_u32 s62, s61, 256
    v_min_i32 v48, s62, v45
    v_max_i32 v238, v238, v48
    v_subrev_u32 v45, 2, v45
    v_min_i32 v48, s62, v45
    v_max_i32 v239, v239, v48
    v_subrev_u32 v45, 2, v45
    v_min_i32 v48, s62, v45
    v_max_i32 v240, v240, v48
    v_subrev_u32 v45, 2, v45
    v_min_i32 v48, s62, v45
    v_max_i32 v241, v241, v48
    v_subrev_u32 v45, 2, v45
    v_min_i32 v48, s62, v45
    v_max_i32 v242, v242, v48
    v_subrev_u32 v45, 2, v45
    v_min_i32 v48, s62, v45
    v_max_i32 v243, v243, v48
    v_subrev_u32 v45, 2, v45
    v_min_i32 v48, s62, v45
    v_max_i32 v244, v244, v48
    v_subrev_u32 v45, 2, v45
    v_min_i32 v48, s62, v45
    v_max_i32 v245, v245, v48
    v_subrev_u32 v45, 2, v45
    v_min_i32 v48, s62, v45
    v_max_i32 v246, v246, v48
L_nofix_1:
    s_waitcnt vmcnt(1)
    s_lshr_b32 s52, s39, 1
    v_lshlrev_b32 v44, 16, v19
    v_mul_f32 v46, 0x3fb8aa3b, v44
    v_mov_b32 v47, 0x3fb8aa3b
    v_fma_f32 v47, v44, v47, -v46
    v_fmamk_f32 v47, v44, 0x32a57060, v47
    v_exp_f32 v45, v46
    v_mul_f32 v47, 0x3f317218, v47
    v_fmac_f32 v45, v45, v47
    v_lshlrev_b32 v12, 16, v12
    v_mul_f32 v46, 0x3fb8aa3b, v12
    v_mov_b32 v47, 0x3fb8aa3b
    v_fma_f32 v47, v12, v47, -v46
    v_fmamk_f32 v47, v12, 0x32a57060, v47
    v_exp_f32 v44, v46
    v_mul_f32 v47, 0x3f317218, v47
    v_fmac_f32 v44, v44, v47
    v_cvt_pk_bf16_f32 v45, v45, v44
    v_and_b32 v44, s44, v45
    v_lshlrev_b32 v45, 16, v45
    v_lshlrev_b32 v13, 16, v13
    v_lshlrev_b32 v14, 16, v14
    v_lshlrev_b32 v15, 16, v15
    v_mul_f32 v44, v44, v45
    v_mul_f32 v13, v13, v45
    v_mul_f32 v38, 0xbfb8aa3b, v44
    v_mul_f32 v39, 0.15915494, v13
    v_add_f32 v45, v45, v45
    v_mul_f32 v32, v14, v45
    v_mul_f32 v33, v15, v45
    v_mul_f32 v46, 0x41000000, v38
    v_mul_f32 v47, 0x41000000, v39
    v_mul_f32 v48, 0x43800000, v38
    v_mul_f32 v49, 0x43800000, v39
    v_exp_f32 v46, v46
    v_fract_f32 v47, v47
    v_exp_f32 v48, v48
    v_fract_f32 v49, v49
    v_exp_f32 v50, v38
    v_fract_f32 v51, v39
    v_cos_f32 v26, v47
    v_sin_f32 v27, v47
    v_cos_f32 v28, v49
    v_sin_f32 v29, v49
    v_cos_f32 v20, v51
    v_sin_f32 v21, v51
    v_pk_mul_f32 v[26:27], v[26:27], v[46:47] op_sel_hi:[1,0]
    v_pk_mul_f32 v[28:29], v[28:29], v[48:49] op_sel_hi:[1,0]
    v_pk_mul_f32 v[20:21], v[20:21], v[50:51] op_sel_hi:[1,0]
    s_waitcnt lgkmcnt(0)
    s_mul_i32 s40, s41, 0x9E3779B1
    s_add_u32 s40, s40, 0x632BE5AB
    s_and_b32 s53, s39, 1
    s_lshl_b32 s53, s53, 6
    v_add_u32 v44, s53, v1
    s_mul_i32 s54, s52, 18432
    v_mul_u32_u24 v43, 144, v44
    v_add_u32 v43, s54, v43
    s_mul_i32 s54, s52, 14336
    s_add_u32 s54, s54, 36864
    v_mul_u32_u24 v42, 112, v44
    v_add_u32 v42, s54, v42
    v_pk_mul_f32 v[30:31], v[26:27], v[26:27] op_sel_hi:[0,1]
    v_pk_fma_f32 v[34:35], v[26:27], v[26:27], v[30:31] op_sel:[1,1,0] op_sel_hi:[1,0,1] neg_lo:[1,0,0]
    v_pk_mul_f32 v[30:31], v[34:35], v[34:35] op_sel_hi:[0,1]
    v_pk_fma_f32 v[36:37], v[34:35], v[34:35], v[30:31] op_sel:[1,1,0] op_sel_hi:[1,0,1] neg_lo:[1,0,0]
    v_pk_mul_f32 v[30:31], v[34:35], v[26:27] op_sel_hi:[0,1]
    v_pk_fma_f32 v[58:59], v[34:35], v[26:27], v[30:31] op_sel:[1,1,0] op_sel_hi:[1,0,1] neg_lo:[1,0,0]
    v_mov_b32 v52, 1.0
    v_mov_b32 v53, 0
    v_mov_b32 v54, v26
    v_mov_b32 v55, v27
    v_mov_b32 v56, v34
    v_mov_b32 v57, v35
    v_cvt_pk_bf16_f32 v60, v52, v54
    v_cvt_pk_bf16_f32 v61, v56, v58
    v_cvt_pk_bf16_f32 v64, v53, v55
    v_cvt_pk_bf16_f32 v65, v57, v59
    v_pk_mul_f32 v[30:31], v[52:53], v[36:37] op_sel_hi:[0,1]
    v_pk_fma_f32 v[52:53], v[52:53], v[36:37], v[30:31] op_sel:[1,1,0] op_sel_hi:[1,0,1] neg_lo:[1,0,0]
    v_pk_mul_f32 v[30:31], v[54:55], v[36:37] op_sel_hi:[0,1]
    v_pk_fma_f32 v[54:55], v[54:55], v[36:37], v[30:31] op_sel:[1,1,0] op_sel_hi:[1,0,1] neg_lo:[1,0,0]
    v_pk_mul_f32 v[30:31], v[56:57], v[36:37] op_sel_hi:[0,1]
    v_pk_fma_f32 v[56:57], v[56:57], v[36:37], v[30:31] op_sel:[1,1,0] op_sel_hi:[1,0,1] neg_lo:[1,0,0]
    v_pk_mul_f32 v[30:31], v[58:59], v[36:37] op_sel_hi:[0,1]
    v_pk_fma_f32 v[58:59], v[58:59], v[36:37], v[30:31] op_sel:[1,1,0] op_sel_hi:[1,0,1] neg_lo:[1,0,0]
    v_cvt_pk_bf16_f32 v62, v52, v54
    v_cvt_pk_bf16_f32 v63, v56, v58
    v_cvt_pk_bf16_f32 v66, v53, v55
    v_cvt_pk_bf16_f32 v67, v57, v59
    v_pk_mul_f32 v[30:31], v[52:53], v[36:37] op_sel_hi:[0,1]
    v_pk_fma_f32 v[52:53], v[52:53], v[36:37], v[30:31] op_sel:[1,1,0] op_sel_hi:[1,0,1] neg_lo:[1,0,0]
    v_pk_mul_f32 v[30:31], v[54:55], v[36:37] op_sel_hi:[0,1]
    v_pk_fma_f32 v[54:55], v[54:55], v[36:37], v[30:31] op_sel:[1,1,0] op_sel_hi:[1,0,1] neg_lo:[1,0,0]
    v_pk_mul_f32 v[30:31], v[56:57], v[36:37] op_sel_hi:[0,1]
    v_pk_fma_f32 v[56:57], v[56:57], v[36:37], v[30:31] op_sel:[1,1,0] op_sel_hi:[1,0,1] neg_lo:[1,0,0]
    v_pk_mul_f32 v[30:31], v[58:59], v[36:37] op_sel_hi:[0,1]
    v_pk_fma_f32 v[58:59], v[58:59], v[36:37], v[30:31] op_sel:[1,1,0] op_sel_hi:[1,0,1] neg_lo:[1,0,0]
    ds_write_b128 v43, v[60:63] offset:0
    ds_write_b128 v43, v[64:67] offset:64
    v_cvt_pk_bf16_f32 v60, v52, v54
    v_cvt_pk_bf16_f32 v61, v56, v58
    v_cvt_pk_bf16_f32 v64, v53, v55
    v_cvt_pk_bf16_f32 v65, v57, v59
    v_pk_mul_f32 v[30:31], v[52:53], v[36:37] op_sel_hi:[0,1]
    v_pk_fma_f32 v[52:53], v[52:53], v[36:37], v[30:31] op_sel:[1,1,0] op_sel_hi:[1,0,1] neg_lo:[1,0,0]
    v_pk_mul_f32 v[30:31], v[54:55], v[36:37] op_sel_hi:[0,1]
    v_pk_fma_f32 v[54:55], v[54:55], v[36:37], v[30:31] op_sel:[1,1,0] op_sel_hi:[1,0,1] neg_lo:[1,0,0]
    v_pk_mul_f32 v[30:31], v[56:57], v[36:37] op_sel_hi:[0,1]
    v_pk_fma_f32 v[56:57], v[56:57], v[36:37], v[30:31] op_sel:[1,1,0] op_sel_hi:[1,0,1] neg_lo:[1,0,0]
    v_pk_mul_f32 v[30:31], v[58:59], v[36:37] op_sel_hi:[0,1]
    v_pk_fma_f32 v[58:59], v[58:59], v[36:37], v[30:31] op_sel:[1,1,0] op_sel_hi:[1,0,1] neg_lo:[1,0,0]
    v_cvt_pk_bf16_f32 v62, v52, v54
    v_cvt_pk_bf16_f32 v63, v56, v58
    v_cvt_pk_bf16_f32 v66, v53, v55
    v_cvt_pk_bf16_f32 v67, v57, v59
    v_pk_mul_f32 v[30:31], v[52:53], v[36:37] op_sel_hi:[0,1]
    v_pk_fma_f32 v[52:53], v[52:53], v[36:37], v[30:31] op_sel:[1,1,0] op_sel_hi:[1,0,1] neg_lo:[1,0,0]
    v_pk_mul_f32 v[30:31], v[54:55], v[36:37] op_sel_hi:[0,1]
    v_pk_fma_f32 v[54:55], v[54:55], v[36:37], v[30:31] op_sel:[1,1,0] op_sel_hi:[1,0,1] neg_lo:[1,0,0]
    v_pk_mul_f32 v[30:31], v[56:57], v[36:37] op_sel_hi:[0,1]
    v_pk_fma_f32 v[56:57], v[56:57], v[36:37], v[30:31] op_sel:[1,1,0] op_sel_hi:[1,0,1] neg_lo:[1,0,0]
    v_pk_mul_f32 v[30:31], v[58:59], v[36:37] op_sel_hi:[0,1]
    v_pk_fma_f32 v[58:59], v[58:59], v[36:37], v[30:31] op_sel:[1,1,0] op_sel_hi:[1,0,1] neg_lo:[1,0,0]
    ds_write_b128 v43, v[60:63] offset:16
    ds_write_b128 v43, v[64:67] offset:80
    v_cvt_pk_bf16_f32 v60, v52, v54
    v_cvt_pk_bf16_f32 v61, v56, v58
    v_cvt_pk_bf16_f32 v64, v53, v55
    v_cvt_pk_bf16_f32 v65, v57, v59
    v_pk_mul_f32 v[30:31], v[52:53], v[36:37] op_sel_hi:[0,1]
    v_pk_fma_f32 v[52:53], v[52:53], v[36:37], v[30:31] op_sel:[1,1,0] op_sel_hi:[1,0,1] neg_lo:[1,0,0]
    v_pk_mul_f32 v[30:31], v[54:55], v[36:37] op_sel_hi:[0,1]
    v_pk_fma_f32 v[54:55], v[54:55], v[36:37], v[30:31] op_sel:[1,1,0] op_sel_hi:[1,0,1] neg_lo:[1,0,0]
    v_pk_mul_f32 v[30:31], v[56:57], v[36:37] op_sel_hi:[0,1]
    v_pk_fma_f32 v[56:57], v[56:57], v[36:37], v[30:31] op_sel:[1,1,0] op_sel_hi:[1,0,1] neg_lo:[1,0,0]
    v_pk_mul_f32 v[30:31], v[58:59], v[36:37] op_sel_hi:[0,1]
    v_pk_fma_f32 v[58:59], v[58:59], v[36:37], v[30:31] op_sel:[1,1,0] op_sel_hi:[1,0,1] neg_lo:[1,0,0]
    v_cvt_pk_bf16_f32 v62, v52, v54
    v_cvt_pk_bf16_f32 v63, v56, v58
    v_cvt_pk_bf16_f32 v66, v53, v55
    v_cvt_pk_bf16_f32 v67, v57, v59
    v_pk_mul_f32 v[30:31], v[52:53], v[36:37] op_sel_hi:[0,1]
    v_pk_fma_f32 v[52:53], v[52:53], v[36:37], v[30:31] op_sel:[1,1,0] op_sel_hi:[1,0,1] neg_lo:[1,0,0]
    v_pk_mul_f32 v[30:31], v[54:55], v[36:37] op_sel_hi:[0,1]
    v_pk_fma_f32 v[54:55], v[54:55], v[36:37], v[30:31] op_sel:[1,1,0] op_sel_hi:[1,0,1] neg_lo:[1,0,0]
    v_pk_mul_f32 v[30:31], v[56:57], v[36:37] op_sel_hi:[0,1]
    v_pk_fma_f32 v[56:57], v[56:57], v[36:37], v[30:31] op_sel:[1,1,0] op_sel_hi:[1,0,1] neg_lo:[1,0,0]
    v_pk_mul_f32 v[30:31], v[58:59], v[36:37] op_sel_hi:[0,1]
    v_pk_fma_f32 v[58:59], v[58:59], v[36:37], v[30:31] op_sel:[1,1,0] op_sel_hi:[1,0,1] neg_lo:[1,0,0]
    ds_write_b128 v43, v[60:63] offset:32
    ds_write_b128 v43, v[64:67] offset:96
    v_cvt_pk_bf16_f32 v60, v52, v54
    v_cvt_pk_bf16_f32 v61, v56, v58
    v_cvt_pk_bf16_f32 v64, v53, v55
    v_cvt_pk_bf16_f32 v65, v57, v59
    v_pk_mul_f32 v[30:31], v[52:53], v[36:37] op_sel_hi:[0,1]
    v_pk_fma_f32 v[52:53], v[52:53], v[36:37], v[30:31] op_sel:[1,1,0] op_sel_hi:[1,0,1] neg_lo:[1,0,0]
    v_pk_mul_f32 v[30:31], v[54:55], v[36:37] op_sel_hi:[0,1]
    v_pk_fma_f32 v[54:55], v[54:55], v[36:37], v[30:31] op_sel:[1,1,0] op_sel_hi:[1,0,1] neg_lo:[1,0,0]
    v_pk_mul_f32 v[30:31], v[56:57], v[36:37] op_sel_hi:[0,1]
    v_pk_fma_f32 v[56:57], v[56:57], v[36:37], v[30:31] op_sel:[1,1,0] op_sel_hi:[1,0,1] neg_lo:[1,0,0]
    v_pk_mul_f32 v[30:31], v[58:59], v[36:37] op_sel_hi:[0,1]
    v_pk_fma_f32 v[58:59], v[58:59], v[36:37], v[30:31] op_sel:[1,1,0] op_sel_hi:[1,0,1] neg_lo:[1,0,0]
    v_cvt_pk_bf16_f32 v62, v52, v54
    v_cvt_pk_bf16_f32 v63, v56, v58
    v_cvt_pk_bf16_f32 v66, v53, v55
    v_cvt_pk_bf16_f32 v67, v57, v59
    ds_write_b128 v43, v[60:63] offset:48
    ds_write_b128 v43, v[64:67] offset:112
    v_lshlrev_b32 v2, 4, v1
    s_cmp_eq_u32 s39, 3
    s_cbranch_scc0 L_no_wpf
    s_mul_i32 s52, s38, 5504
    v_add_u32 v17, s52, v2
    v_add_u32 v18, 4096, v17
    v_min_u32 v19, 1409008, v18
    v_add_u32 v19, 1024, v18
    v_min_u32 v19, 1409008, v19
    global_load_dwordx4 v[228:231], v17, s[22:23] offset:0
    global_load_dwordx4 v[228:231], v17, s[22:23] offset:1024
    global_load_dwordx4 v[228:231], v17, s[22:23] offset:2048
    global_load_dwordx4 v[228:231], v17, s[22:23] offset:3072
    global_load_dwordx4 v[228:231], v18, s[22:23]
    global_load_dwordx4 v[228:231], v19, s[22:23]
    global_load_dwordx4 v[228:231], v17, s[24:25] offset:0
    global_load_dwordx4 v[228:231], v17, s[24:25] offset:1024
    global_load_dwordx4 v[228:231], v17, s[24:25] offset:2048
    global_load_dwordx4 v[228:231], v17, s[24:25] offset:3072
    global_load_dwordx4 v[228:231], v18, s[24:25]
    global_load_dwordx4 v[228:231], v19, s[24:25]
    global_load_dwordx4 v[228:231], v17, s[26:27] offset:0
    global_load_dwordx4 v[228:231], v17, s[26:27] offset:1024
    global_load_dwordx4 v[228:231], v17, s[26:27] offset:2048
    global_load_dwordx4 v[228:231], v17, s[26:27] offset:3072
    global_load_dwordx4 v[228:231], v18, s[26:27]
    global_load_dwordx4 v[228:231], v19, s[26:27]
L_no_wpf:
    v_pk_mul_f32 v[30:31], v[20:21], v[20:21] op_sel_hi:[0,1]
    v_pk_fma_f32 v[22:23], v[20:21], v[20:21], v[30:31] op_sel:[1,1,0] op_sel_hi:[1,0,1] neg_lo:[1,0,0]
    v_pk_mul_f32 v[30:31], v[22:23], v[22:23] op_sel_hi:[0,1]
    v_pk_fma_f32 v[24:25], v[22:23], v[22:23], v[30:31] op_sel:[1,1,0] op_sel_hi:[1,0,1] neg_lo:[1,0,0]
    v_mov_b32 v68, v32
    v_mov_b32 v69, v33
    v_pk_mul_f32 v[30:31], v[68:69], v[20:21] op_sel_hi:[0,1]
    v_pk_fma_f32 v[70:71], v[68:69], v[20:21], v[30:31] op_sel:[1,1,0] op_sel_hi:[1,0,1] neg_lo:[1,0,0]
    v_pk_mul_f32 v[30:31], v[70:71], v[20:21] op_sel_hi:[0,1]
    v_pk_fma_f32 v[72:73], v[70:71], v[20:21], v[30:31] op_sel:[1,1,0] op_sel_hi:[1,0,1] neg_lo:[1,0,0]
    v_pk_mul_f32 v[30:31], v[72:73], v[20:21] op_sel_hi:[0,1]
    v_pk_fma_f32 v[74:75], v[72:73], v[20:21], v[30:31] op_sel:[1,1,0] op_sel_hi:[1,0,1] neg_lo:[1,0,0]
    v_pk_mul_f32 v[30:31], v[74:75], v[20:21] op_sel_hi:[0,1]
    v_pk_fma_f32 v[76:77], v[74:75], v[20:21], v[30:31] op_sel:[1,1,0] op_sel_hi:[1,0,1] neg_lo:[1,0,0]
    v_pk_mul_f32 v[30:31], v[76:77], v[20:21] op_sel_hi:[0,1]
    v_pk_fma_f32 v[78:79], v[76:77], v[20:21], v[30:31] op_sel:[1,1,0] op_sel_hi:[1,0,1] neg_lo:[1,0,0]
    v_pk_mul_f32 v[30:31], v[78:79], v[20:21] op_sel_hi:[0,1]
    v_pk_fma_f32 v[80:81], v[78:79], v[20:21], v[30:31] op_sel:[1,1,0] op_sel_hi:[1,0,1] neg_lo:[1,0,0]
    v_pk_mul_f32 v[30:31], v[80:81], v[20:21] op_sel_hi:[0,1]
    v_pk_fma_f32 v[82:83], v[80:81], v[20:21], v[30:31] op_sel:[1,1,0] op_sel_hi:[1,0,1] neg_lo:[1,0,0]
    v_cvt_pk_bf16_f32 v60, v68, v70
    v_cvt_pk_bf16_f32 v64, -v69, -v71
    v_cvt_pk_bf16_f32 v61, v72, v74
    v_cvt_pk_bf16_f32 v65, -v73, -v75
    v_cvt_pk_bf16_f32 v62, v76, v78
    v_cvt_pk_bf16_f32 v66, -v77, -v79
    v_cvt_pk_bf16_f32 v63, v80, v82
    v_cvt_pk_bf16_f32 v67, -v81, -v83
    ds_write_b128 v42, v[60:63] offset:0
    ds_write_b128 v42, v[64:67] offset:32
    v_pk_mul_f32 v[30:31], v[32:33], v[28:29] op_sel_hi:[0,1]
    v_pk_fma_f32 v[68:69], v[32:33], v[28:29], v[30:31] op_sel:[1,1,0] op_sel_hi:[1,0,1] neg_lo:[1,0,0]
    v_pk_mul_f32 v[30:31], v[68:69], v[22:23] op_sel_hi:[0,1]
    v_pk_fma_f32 v[70:71], v[68:69], v[22:23], v[30:31] op_sel:[1,1,0] op_sel_hi:[1,0,1] neg_lo:[1,0,0]
    v_pk_mul_f32 v[30:31], v[70:71], v[22:23] op_sel_hi:[0,1]
    v_pk_fma_f32 v[72:73], v[70:71], v[22:23], v[30:31] op_sel:[1,1,0] op_sel_hi:[1,0,1] neg_lo:[1,0,0]
    v_pk_mul_f32 v[30:31], v[72:73], v[22:23] op_sel_hi:[0,1]
    v_pk_fma_f32 v[74:75], v[72:73], v[22:23], v[30:31] op_sel:[1,1,0] op_sel_hi:[1,0,1] neg_lo:[1,0,0]
    v_pk_mul_f32 v[30:31], v[68:69], v[28:29] op_sel_hi:[0,1]
    v_pk_fma_f32 v[76:77], v[68:69], v[28:29], v[30:31] op_sel:[1,1,0] op_sel_hi:[1,0,1] neg_lo:[1,0,0]
    v_pk_mul_f32 v[30:31], v[76:77], v[24:25] op_sel_hi:[0,1]
    v_pk_fma_f32 v[78:79], v[76:77], v[24:25], v[30:31] op_sel:[1,1,0] op_sel_hi:[1,0,1] neg_lo:[1,0,0]
    v_pk_mul_f32 v[30:31], v[76:77], v[28:29] op_sel_hi:[0,1]
    v_pk_fma_f32 v[80:81], v[76:77], v[28:29], v[30:31] op_sel:[1,1,0] op_sel_hi:[1,0,1] neg_lo:[1,0,0]
    v_pk_mul_f32 v[30:31], v[80:81], v[24:25] op_sel_hi:[0,1]
    v_pk_fma_f32 v[82:83], v[80:81], v[24:25], v[30:31] op_sel:[1,1,0] op_sel_hi:[1,0,1] neg_lo:[1,0,0]
    v_pk_mul_f32 v[30:31], v[80:81], v[28:29] op_sel_hi:[0,1]
    v_pk_fma_f32 v[32:33], v[80:81], v[28:29], v[30:31] op_sel:[1,1,0] op_sel_hi:[1,0,1] neg_lo:[1,0,0]
    v_cvt_pk_bf16_f32 v60, v68, v70
    v_cvt_pk_bf16_f32 v64, -v69, -v71
    v_cvt_pk_bf16_f32 v61, v72, v74
    v_cvt_pk_bf16_f32 v65, -v73, -v75
    v_cvt_pk_bf16_f32 v62, v76, v78
    v_cvt_pk_bf16_f32 v66, -v77, -v79
    v_cvt_pk_bf16_f32 v63, v80, v82
    v_cvt_pk_bf16_f32 v67, -v81, -v83
    ds_write_b128 v42, v[60:63] offset:16
    ds_write_b128 v42, v[64:67] offset:48
    v_mov_b32 v68, v32
    v_mov_b32 v69, v33
    v_pk_mul_f32 v[30:31], v[68:69], v[28:29] op_sel_hi:[0,1]
    v_pk_fma_f32 v[70:71], v[68:69], v[28:29], v[30:31] op_sel:[1,1,0] op_sel_hi:[1,0,1] neg_lo:[1,0,0]
    v_pk_mul_f32 v[30:31], v[70:71], v[28:29] op_sel_hi:[0,1]
    v_pk_fma_f32 v[72:73], v[70:71], v[28:29], v[30:31] op_sel:[1,1,0] op_sel_hi:[1,0,1] neg_lo:[1,0,0]
    v_pk_mul_f32 v[30:31], v[72:73], v[28:29] op_sel_hi:[0,1]
    v_pk_fma_f32 v[74:75], v[72:73], v[28:29], v[30:31] op_sel:[1,1,0] op_sel_hi:[1,0,1] neg_lo:[1,0,0]
    v_pk_mul_f32 v[30:31], v[74:75], v[28:29] op_sel_hi:[0,1]
    v_pk_fma_f32 v[76:77], v[74:75], v[28:29], v[30:31] op_sel:[1,1,0] op_sel_hi:[1,0,1] neg_lo:[1,0,0]
    v_cvt_pk_bf16_f32 v60, v68, v70
    v_cvt_pk_bf16_f32 v64, -v69, -v71
    v_cvt_pk_bf16_f32 v61, v72, v74
    v_cvt_pk_bf16_f32 v65, -v73, -v75
    v_cvt_pk_bf16_f32 v62, v76, v76
    v_cvt_pk_bf16_f32 v66, -v77, -v77
    v_cvt_pk_bf16_f32 v63, v76, v76
    v_cvt_pk_bf16_f32 v67, -v77, -v77
    ds_write_b128 v42, v[60:63] offset:64
    ds_write_b128 v42, v[64:67] offset:80
    v_mov_b32 v44, 86860
    v_mov_b32 v45, 1
    s_waitcnt lgkmcnt(0)
    s_mov_b64 exec, 1
    ds_add_u32 v44, v45
    s_mov_b64 exec, -1
    s_mov_b32 s47, 0
L_ks_2:
    s_add_u32 s47, s47, 1
    s_cmp_gt_u32 s47, 40000
    s_cbranch_scc1 L_ksx_3
    ds_read_b32 v45, v44
    s_waitcnt lgkmcnt(0)
    v_cmp_gt_u32 vcc, 4, v45
    s_cbranch_vccnz L_ks_2
L_ksx_3:
    v_lshlrev_b32 v170, 6, v0
    v_add_u32 v170, 1441792, v170
    v_add_u32 v171, 8192, v170
    s_cmp_lt_u32 s39, 2
    s_cbranch_scc0 L_no_s0a_ld
    global_load_dword v172, v170, s[36:37] sc1
    global_load_dword v173, v171, s[36:37] sc1
L_no_s0a_ld:
    s_lshr_b32 s52, s39, 1
    s_and_b32 s53, s39, 1
    v_and_b32 v44, 15, v1
    v_lshrrev_b32 v45, 4, v1
    v_lshrrev_b32 v46, 2, v44
    v_lshl_add_u32 v46, v45, 2, v46
    v_and_b32 v47, 3, v1
    v_lshlrev_b32 v47, 3, v47
    v_mul_u32_u24 v48, 112, v46
    v_mul_u32_u24 v49, 144, v46
    s_mul_i32 s54, s52, 14336
    s_add_u32 s54, s54, 36864
    v_add3_u32 v48, v48, v47, s54
    s_mul_i32 s54, s52, 18432
    s_lshl_b32 s55, s53, 5
    s_add_u32 s54, s54, s55
    v_add3_u32 v49, v49, v47, s54
    ds_read_b64_tr_b16 v[64:65], v48 offset:0
    ds_read_b64_tr_b16 v[66:67], v48 offset:32
    ds_read_b64_tr_b16 v[128:129], v49 offset:0
    ds_read_b64_tr_b16 v[130:131], v49 offset:64
    ds_read_b64_tr_b16 v[96:97], v48 offset:64
    ds_read_b64_tr_b16 v[98:99], v48 offset:80
    ds_read_b64_tr_b16 v[68:69], v48 offset:1792
    ds_read_b64_tr_b16 v[70:71], v48 offset:1824
    ds_read_b64_tr_b16 v[132:133], v49 offset:2304
    ds_read_b64_tr_b16 v[134:135], v49 offset:2368
    ds_read_b64_tr_b16 v[100:101], v48 offset:1856
    ds_read_b64_tr_b16 v[102:103], v48 offset:1872
    s_waitcnt lgkmcnt(6)
    v_mfma_f32_16x16x32_bf16 v[160:163], v[64:67], v[128:131], 0
    v_mfma_f32_16x16x32_bf16 v[164:167], v[96:99], v[128:131], 0
    ds_read_b64_tr_b16 v[72:73], v48 offset:3584
    ds_read_b64_tr_b16 v[74:75], v48 offset:3616
    ds_read_b64_tr_b16 v[136:137], v49 offset:4608
    ds_read_b64_tr_b16 v[138:139], v49 offset:4672
    ds_read_b64_tr_b16 v[104:105], v48 offset:3648
    ds_read_b64_tr_b16 v[106:107], v48 offset:3664
    s_waitcnt lgkmcnt(6)
    v_mfma_f32_16x16x32_bf16 v[160:163], v[68:71], v[132:135], v[160:163]
    v_mfma_f32_16x16x32_bf16 v[164:167], v[100:103], v[132:135], v[164:167]
    ds_read_b64_tr_b16 v[76:77], v48 offset:5376
    ds_read_b64_tr_b16 v[78:79], v48 offset:5408
    ds_read_b64_tr_b16 v[140:141], v49 offset:6912
    ds_read_b64_tr_b16 v[142:143], v49 offset:6976
    ds_read_b64_tr_b16 v[108:109], v48 offset:5440
    ds_read_b64_tr_b16 v[110:111], v48 offset:5456
    s_waitcnt lgkmcnt(6)
    v_mfma_f32_16x16x32_bf16 v[160:163], v[72:75], v[136:139], v[160:163]
    v_mfma_f32_16x16x32_bf16 v[164:167], v[104:107], v[136:139], v[164:167]
    ds_read_b64_tr_b16 v[80:81], v48 offset:7168
    ds_read_b64_tr_b16 v[82:83], v48 offset:7200
    ds_read_b64_tr_b16 v[144:145], v49 offset:9216
    ds_read_b64_tr_b16 v[146:147], v49 offset:9280
    ds_read_b64_tr_b16 v[112:113], v48 offset:7232
    ds_read_b64_tr_b16 v[114:115], v48 offset:7248
    s_waitcnt lgkmcnt(6)
    v_mfma_f32_16x16x32_bf16 v[160:163], v[76:79], v[140:143], v[160:163]
    v_mfma_f32_16x16x32_bf16 v[164:167], v[108:111], v[140:143], v[164:167]
    ds_read_b64_tr_b16 v[84:85], v48 offset:8960
    ds_read_b64_tr_b16 v[86:87], v48 offset:8992
    ds_read_b64_tr_b16 v[148:149], v49 offset:11520
    ds_read_b64_tr_b16 v[150:151], v49 offset:11584
    ds_read_b64_tr_b16 v[116:117], v48 offset:9024
    ds_read_b64_tr_b16 v[118:119], v48 offset:9040
    s_waitcnt lgkmcnt(6)
    v_mfma_f32_16x16x32_bf16 v[160:163], v[80:83], v[144:147], v[160:163]
    v_mfma_f32_16x16x32_bf16 v[164:167], v[112:115], v[144:147], v[164:167]
    ds_read_b64_tr_b16 v[88:89], v48 offset:10752
    ds_read_b64_tr_b16 v[90:91], v48 offset:10784
    ds_read_b64_tr_b16 v[152:153], v49 offset:13824
    ds_read_b64_tr_b16 v[154:155], v49 offset:13888
    ds_read_b64_tr_b16 v[120:121], v48 offset:10816
    ds_read_b64_tr_b16 v[122:123], v48 offset:10832
    s_waitcnt lgkmcnt(6)
    v_mfma_f32_16x16x32_bf16 v[160:163], v[84:87], v[148:151], v[160:163]
    v_mfma_f32_16x16x32_bf16 v[164:167], v[116:119], v[148:151], v[164:167]
    ds_read_b64_tr_b16 v[92:93], v48 offset:12544
    ds_read_b64_tr_b16 v[94:95], v48 offset:12576
    ds_read_b64_tr_b16 v[156:157], v49 offset:16128
    ds_read_b64_tr_b16 v[158:159], v49 offset:16192
    ds_read_b64_tr_b16 v[124:125], v48 offset:12608
    ds_read_b64_tr_b16 v[126:127], v48 offset:12624
    s_waitcnt lgkmcnt(6)
    v_mfma_f32_16x16x32_bf16 v[160:163], v[88:91], v[152:155], v[160:163]
    v_mfma_f32_16x16x32_bf16 v[164:167], v[120:123], v[152:155], v[164:167]
    s_waitcnt lgkmcnt(0)
    v_mfma_f32_16x16x32_bf16 v[160:163], v[92:95], v[156:159], v[160:163]
    v_mfma_f32_16x16x32_bf16 v[164:167], v[124:127], v[156:159], v[164:167]
    s_lshl_b32 s53, s53, 4
    v_add_u32 v44, s53, v44
    s_lshl_b32 s52, s52, 11
    s_add_u32 s52, s52, 65600
    v_subrev_u32 v48, 1, v45
    v_max_i32 v48, 0, v48
    v_lshlrev_b32 v49, 4, v44
    v_lshrrev_b32 v49, v48, v49
    v_and_b32 v50, 1, v45
    v_lshrrev_b32 v51, 1, v45
    v_mov_b32 v52, 248
    v_mad_u32_u24 v52, v51, v52, 8
    v_mul_u32_u24 v52, v50, v52
    v_lshl_add_u32 v52, v51, 9, v52
    v_add3_u32 v49, v49, v52, s52
    v_and_b32 v50, v50, v51
    v_mov_b32 v52, 124
    v_mad_u32_u24 v50, v50, v52, 4
    v_add_u32 v50, v49, v50
    v_lshlrev_b32 v51, 1, v44
    v_lshl_add_u32 v51, v45, 8, v51
    s_add_u32 s52, s52, 1024
    v_add_u32 v51, s52, v51
    s_lshl_b32 s54, s43, 16
    s_and_b32 s55, s43, s44
    s_cmp_lt_u32 s39, 2
    s_cselect_b32 s54, s54, s55
    s_bitcmp1_b32 s39, 0
    s_cselect_b32 s54, 0, s54
    v_mov_b32 v52, s54
    s_mov_b64 exec, 1
    v_add_f32 v160, v160, v52
    s_mov_b64 exec, -1
    v_cvt_pk_bf16_f32 v52, v160, v161
    v_cvt_pk_bf16_f32 v53, v162, v163
    v_cvt_pk_bf16_f32 v54, v164, v165
    v_cvt_pk_bf16_f32 v55, v166, v167
    ds_write_b32 v49, v52
    ds_write_b32 v50, v53
    ds_write_b16 v51, v54
    ds_write_b16_d16_hi v51, v54 offset:64
    ds_write_b16 v51, v55 offset:128
    ds_write_b16_d16_hi v51, v55 offset:192
    s_cmp_lt_u32 s39, 2
    s_cbranch_scc0 L_s0a_ok
    s_mov_b32 s47, 0
L_s0a_chk:
    s_waitcnt vmcnt(0)
    v_xor_b32 v174, s40, v172
    v_xor_b32 v175, s40, v173
    v_or_b32 v174, v174, v175
    v_cmp_ne_u32 vcc, 0, v174
    s_nop 0
    s_and_b64 exec, exec, vcc
    s_cbranch_execz L_s0a_x
    s_add_u32 s47, s47, 1
    s_cmp_gt_u32 s47, 40000
    s_cbranch_scc1 L_s0a_x
L_s0a_ld2:
    global_load_dword v172, v170, s[36:37] sc1
    global_load_dword v173, v171, s[36:37] sc1
    s_branch L_s0a_chk
L_s0a_x:
    s_mov_b64 exec, -1
L_s0a_ok:
    s_waitcnt lgkmcnt(0)
    s_branch L_b2
L_pro_helper:
    v_subrev_u32 v32, 256, v0
    v_subrev_u32 v33, 4096, v3
    s_min_u32 s52, s38, 191
    s_and_b32 s53, s52, 3
    s_lshr_b32 s52, s52, 2
    s_lshl_b32 s52, s52, 7
    s_lshl_b32 s54, s53, 7
    v_lshrrev_b32 v34, 3, v32
    v_add_u32 v34, s54, v34
    v_mul_u32_u24 v35, 6144, v34
    v_and_b32 v36, 7, v32
    v_lshl_add_u32 v35, v36, 4, v35
    v_add_u32 v35, s52, v35
    v_lshlrev_b32 v34, 1, v34
    s_waitcnt lgkmcnt(0)
    s_cmp_eq_u32 s39, 4
    s_cbranch_scc0 L_no_reset
    v_mov_b32 v40, -1
    v_mov_b32 v41, -1
    v_mov_b32 v42, -1
    v_mov_b32 v43, -1
    s_lshl_b32 s56, s38, 13
    s_add_u32 s56, s56, 4194304
    v_lshlrev_b32 v39, 4, v1
    v_add_u32 v37, s56, v39
    v_add_u32 v38, 4096, v37
    global_store_dwordx4 v37, v[40:43], s[36:37] offset:0 sc1
    global_store_dwordx4 v37, v[40:43], s[36:37] offset:1024 sc1
    global_store_dwordx4 v37, v[40:43], s[36:37] offset:2048 sc1
    global_store_dwordx4 v37, v[40:43], s[36:37] offset:3072 sc1
    global_store_dwordx4 v38, v[40:43], s[36:37] offset:0 sc1
    global_store_dwordx4 v38, v[40:43], s[36:37] offset:1024 sc1
    global_store_dwordx4 v38, v[40:43], s[36:37] offset:2048 sc1
    global_store_dwordx4 v38, v[40:43], s[36:37] offset:3072 sc1
L_no_reset:
    s_cmp_eq_u32 s39, 7
    s_cbranch_scc0 L_no_pt1
    s_and_b32 s56, s38, 3
    s_mul_i32 s56, s56, 24576
    s_lshr_b32 s57, s38, 2
    s_lshl_b32 s57, s57, 9
    s_add_u32 s56, s56, s57
    s_add_u32 s56, s56, 1310720
    v_lshlrev_b32 v37, 7, v1
    v_add_u32 v37, s56, v37
    s_lshl_b32 s56, s38, 6
    s_add_u32 s56, s56, 1441792
    v_mov_b32 v38, s56
    v_cmp_eq_u32 vcc, 4, v1
    s_nop 1
    v_cndmask_b32 v37, v37, v38, vcc
    s_lshl_b32 s56, s38, 3
    s_add_u32 s56, s56, 1507328
    v_mov_b32 v38, s56
    v_cmp_eq_u32 vcc, 5, v1
    s_nop 1
    v_cndmask_b32 v37, v37, v38, vcc
    s_mov_b64 exec, 0x3f
    global_load_dword v38, v37, s[36:37]
    s_mov_b64 exec, -1
L_no_pt1:
    global_load_dwordx4 v[8:11], v33, s[4:5]
    global_load_dwordx4 v[4:7], v3, s[4:5]
    s_load_dword s41, s[36:37], 0
    s_load_dword s43, s[16:17], s50
    s_barrier
    s_sub_u32 s58, s39, 5
    s_cmp_lt_u32 s58, 2
    s_cbranch_scc0 L_no_reset2
    v_mov_b32 v40, -1
    v_mov_b32 v41, -1
    v_mov_b32 v42, -1
    v_mov_b32 v43, -1
    s_lshl_b32 s58, s38, 13
    s_add_u32 s58, s58, 2097152
    s_lshl_b32 s59, s38, 12
    s_add_u32 s59, s59, 65536
    s_cmp_eq_u32 s39, 6
    s_cselect_b32 s58, s59, s58
    v_lshlrev_b32 v37, 4, v1
    v_add_u32 v37, s58, v37
    global_store_dwordx4 v37, v[40:43], s[36:37] offset:0 sc1
    global_store_dwordx4 v37, v[40:43], s[36:37] offset:1024 sc1
    global_store_dwordx4 v37, v[40:43], s[36:37] offset:2048 sc1
    global_store_dwordx4 v37, v[40:43], s[36:37] offset:3072 sc1
    s_cbranch_scc1 L_small_reset
    v_add_u32 v37, 4096, v37
    global_store_dwordx4 v37, v[40:43], s[36:37] offset:0 sc1
    global_store_dwordx4 v37, v[40:43], s[36:37] offset:1024 sc1
    global_store_dwordx4 v37, v[40:43], s[36:37] offset:2048 sc1
    global_store_dwordx4 v37, v[40:43], s[36:37] offset:3072 sc1
    s_branch L_no_reset2
L_small_reset:
    s_lshl_b32 s59, s38, 7
    s_add_u32 s59, s59, 1228792
    s_lshl_b32 s58, s38, 6
    s_add_u32 s58, s58, 1572864
    v_lshlrev_b32 v37, 3, v1
    v_add_u32 v37, s59, v37
    v_mov_b32 v38, s58
    s_cmp_lt_u32 s38, 172
    s_cselect_b32 s58, 1, 64
    v_cmp_gt_u32 vcc, s58, v1
    s_nop 1
    v_cndmask_b32 v37, v37, v38, vcc
    s_mov_b64 exec, 0x1f
    global_store_dwordx2 v37, v[40:41], s[36:37] sc1
    s_mov_b64 exec, -1
L_no_reset2:
    global_load_ushort v12, v34, s[28:29] offset:0
    global_load_ushort v13, v34, s[28:29] offset:64
    global_load_ushort v14, v34, s[28:29] offset:128
    global_load_ushort v15, v34, s[28:29] offset:192
    global_load_dwordx4 v[16:19], v35, s[30:31]
    v_add_u32 v35, 196608, v35
    global_load_dwordx4 v[20:23], v35, s[30:31]
    v_add_u32 v35, 196608, v35
    global_load_dwordx4 v[24:27], v35, s[30:31]
    v_add_u32 v35, 196608, v35
    global_load_dwordx4 v[28:31], v35, s[30:31]
    v_and_b32 v44, 255, v0
    v_lshlrev_b32 v45, 3, v44
    v_sub_u32 v45, 2048, v45
    v_cvt_f32_u32 v64, v45
    s_lshr_b32 s60, s39, 2
    s_lshl_b32 s61, s60, 11
    s_add_u32 s61, s61, 65600
    s_sub_u32 s62, s61, 0x8500
    v_mov_b32 v47, s62
    v_add_f32 v65, -1.0, v64
    v_add_f32 v66, -1.0, v65
    v_add_f32 v67, -1.0, v66
    v_add_f32 v68, -1.0, v67
    v_add_f32 v69, -1.0, v68
    v_add_f32 v70, -1.0, v69
    v_add_f32 v71, -1.0, v70
    v_add_f32 v72, -1.0, v71
    v_cvt_pk_bf16_f32 v84, v64, v65
    v_cvt_pk_bf16_f32 v85, v66, v67
    v_cvt_pk_bf16_f32 v86, v68, v69
    v_cvt_pk_bf16_f32 v87, v70, v71
    v_cvt_pk_bf16_f32 v88, v72, v72
    v_mad_u32_u16 v238, v84, 2, v47 op_sel:[0,0,0,0]
    v_mad_u32_u16 v239, v84, 2, v47 op_sel:[1,0,0,0]
    v_mad_u32_u16 v240, v85, 2, v47 op_sel:[0,0,0,0]
    v_mad_u32_u16 v241, v85, 2, v47 op_sel:[1,0,0,0]
    v_mad_u32_u16 v242, v86, 2, v47 op_sel:[0,0,0,0]
    v_mad_u32_u16 v243, v86, 2, v47 op_sel:[1,0,0,0]
    v_mad_u32_u16 v244, v87, 2, v47 op_sel:[0,0,0,0]
    v_mad_u32_u16 v245, v87, 2, v47 op_sel:[1,0,0,0]
    v_mad_u32_u16 v246, v88, 2, v47 op_sel:[0,0,0,0]
    s_and_b32 s62, s39, 3
    s_cmp_eq_u32 s62, 3
    s_cbranch_scc0 L_nofix_4
    v_lshl_add_u32 v45, v45, 1, s61
    s_add_u32 s62, s61, 256
    v_min_i32 v48, s62, v45
    v_max_i32 v238, v238, v48
    v_subrev_u32 v45, 2, v45
    v_min_i32 v48, s62, v45
    v_max_i32 v239, v239, v48
    v_subrev_u32 v45, 2, v45
    v_min_i32 v48, s62, v45
    v_max_i32 v240, v240, v48
    v_subrev_u32 v45, 2, v45
    v_min_i32 v48, s62, v45
    v_max_i32 v241, v241, v48
    v_subrev_u32 v45, 2, v45
    v_min_i32 v48, s62, v45
    v_max_i32 v242, v242, v48
    v_subrev_u32 v45, 2, v45
    v_min_i32 v48, s62, v45
    v_max_i32 v243, v243, v48
    v_subrev_u32 v45, 2, v45
    v_min_i32 v48, s62, v45
    v_max_i32 v244, v244, v48
    v_subrev_u32 v45, 2, v45
    v_min_i32 v48, s62, v45
    v_max_i32 v245, v245, v48
    v_subrev_u32 v45, 2, v45
    v_min_i32 v48, s62, v45
    v_max_i32 v246, v246, v48
L_nofix_4:
    s_setprio 3
    s_cmp_eq_u32 s39, 5
    s_cbranch_scc1 L_xw16
    s_cmp_eq_u32 s39, 6
    s_cbranch_scc1 L_xw13
    s_waitcnt vmcnt(8)
    s_branch L_xw_done
L_xw13:
    s_waitcnt vmcnt(13)
    s_branch L_xw_done
L_xw16:
    s_waitcnt vmcnt(16)
L_xw_done:
    s_cmp_eq_u32 s39, 4
    s_cbranch_scc0 L_no_s0a
    s_waitcnt lgkmcnt(0)
    s_mul_i32 s40, s41, 0x9E3779B1
    s_add_u32 s40, s40, 0x632BE5AB
    s_lshl_b32 s56, s38, 6
    s_add_u32 s56, s56, 1441792
    v_mov_b32 v73, s56
    v_mov_b32 v74, s40
    s_mov_b64 exec, 1
    global_store_dword v73, v74, s[36:37] sc1
    s_mov_b64 exec, -1
L_no_s0a:
    v_lshlrev_b32 v44, 16, v8
    v_and_b32 v45, s44, v8
    v_lshlrev_b32 v46, 16, v9
    v_and_b32 v47, s44, v9
    v_lshlrev_b32 v48, 16, v10
    v_and_b32 v49, s44, v10
    v_lshlrev_b32 v50, 16, v11
    v_and_b32 v51, s44, v11
    v_lshlrev_b32 v52, 16, v4
    v_and_b32 v53, s44, v4
    v_lshlrev_b32 v54, 16, v5
    v_and_b32 v55, s44, v5
    v_lshlrev_b32 v56, 16, v6
    v_and_b32 v57, s44, v6
    v_lshlrev_b32 v58, 16, v7
    v_and_b32 v59, s44, v7
    v_readfirstlane_b32 s52, v44
    v_readfirstlane_b32 s54, v52
    s_nop 0
    v_pk_add_f32 v[44:45], v[44:45], s[52:53] op_sel_hi:[1,0] neg_lo:[0,1] neg_hi:[0,1]
    v_pk_add_f32 v[46:47], v[46:47], s[52:53] op_sel_hi:[1,0] neg_lo:[0,1] neg_hi:[0,1]
    v_pk_add_f32 v[48:49], v[48:49], s[52:53] op_sel_hi:[1,0] neg_lo:[0,1] neg_hi:[0,1]
    v_pk_add_f32 v[50:51], v[50:51], s[52:53] op_sel_hi:[1,0] neg_lo:[0,1] neg_hi:[0,1]
    v_pk_add_f32 v[52:53], v[52:53], s[54:55] op_sel_hi:[1,0] neg_lo:[0,1] neg_hi:[0,1]
    v_pk_add_f32 v[54:55], v[54:55], s[54:55] op_sel_hi:[1,0] neg_lo:[0,1] neg_hi:[0,1]
    v_pk_add_f32 v[56:57], v[56:57], s[54:55] op_sel_hi:[1,0] neg_lo:[0,1] neg_hi:[0,1]
    v_pk_add_f32 v[58:59], v[58:59], s[54:55] op_sel_hi:[1,0] neg_lo:[0,1] neg_hi:[0,1]
    v_pk_add_f32 v[60:61], v[44:45], v[46:47]
    v_pk_mul_f32 v[62:63], v[44:45], v[44:45]
    v_pk_add_f32 v[64:65], v[48:49], v[50:51]
    v_pk_fma_f32 v[62:63], v[46:47], v[46:47], v[62:63]
    v_pk_add_f32 v[60:61], v[60:61], v[64:65]
    v_pk_fma_f32 v[62:63], v[48:49], v[48:49], v[62:63]
    v_add_f32 v60, v60, v61
    v_pk_fma_f32 v[62:63], v[50:51], v[50:51], v[62:63]
    v_add_f32 v62, v62, v63
    v_pk_add_f32 v[66:67], v[52:53], v[54:55]
    v_pk_mul_f32 v[68:69], v[52:53], v[52:53]
    v_pk_add_f32 v[70:71], v[56:57], v[58:59]
    v_pk_fma_f32 v[68:69], v[54:55], v[54:55], v[68:69]
    v_pk_add_f32 v[66:67], v[66:67], v[70:71]
    v_pk_fma_f32 v[68:69], v[56:57], v[56:57], v[68:69]
    v_add_f32 v66, v66, v67
    v_pk_fma_f32 v[68:69], v[58:59], v[58:59], v[68:69]
    v_add_f32 v68, v68, v69
    v_add_f32_dpp v60, v60, v60 row_shr:1 row_mask:0xf bank_mask:0xf
    v_add_f32_dpp v62, v62, v62 row_shr:1 row_mask:0xf bank_mask:0xf
    v_add_f32_dpp v66, v66, v66 row_shr:1 row_mask:0xf bank_mask:0xf
    v_add_f32_dpp v68, v68, v68 row_shr:1 row_mask:0xf bank_mask:0xf
    v_add_f32_dpp v60, v60, v60 row_shr:2 row_mask:0xf bank_mask:0xf
    v_add_f32_dpp v62, v62, v62 row_shr:2 row_mask:0xf bank_mask:0xf
    v_add_f32_dpp v66, v66, v66 row_shr:2 row_mask:0xf bank_mask:0xf
    v_add_f32_dpp v68, v68, v68 row_shr:2 row_mask:0xf bank_mask:0xf
    v_add_f32_dpp v60, v60, v60 row_shr:4 row_mask:0xf bank_mask:0xf
    v_add_f32_dpp v62, v62, v62 row_shr:4 row_mask:0xf bank_mask:0xf
    v_add_f32_dpp v66, v66, v66 row_shr:4 row_mask:0xf bank_mask:0xf
    v_add_f32_dpp v68, v68, v68 row_shr:4 row_mask:0xf bank_mask:0xf
    v_add_f32_dpp v60, v60, v60 row_shr:8 row_mask:0xf bank_mask:0xf
    v_add_f32_dpp v62, v62, v62 row_shr:8 row_mask:0xf bank_mask:0xf
    v_add_f32_dpp v66, v66, v66 row_shr:8 row_mask:0xf bank_mask:0xf
    v_add_f32_dpp v68, v68, v68 row_shr:8 row_mask:0xf bank_mask:0xf
    v_add_f32_dpp v60, v60, v60 row_bcast:15 row_mask:0xa bank_mask:0xf
    v_add_f32_dpp v62, v62, v62 row_bcast:15 row_mask:0xa bank_mask:0xf
    v_add_f32_dpp v66, v66, v66 row_bcast:15 row_mask:0xa bank_mask:0xf
    v_add_f32_dpp v68, v68, v68 row_bcast:15 row_mask:0xa bank_mask:0xf
    v_add_f32_dpp v60, v60, v60 row_bcast:31 row_mask:0xc bank_mask:0xf
    v_add_f32_dpp v62, v62, v62 row_bcast:31 row_mask:0xc bank_mask:0xf
    v_add_f32_dpp v66, v66, v66 row_bcast:31 row_mask:0xc bank_mask:0xf
    v_add_f32_dpp v68, v68, v68 row_bcast:31 row_mask:0xc bank_mask:0xf
    v_mul_f32 v60, 0x3b000000, v60
    v_mul_f32 v62, 0x3b000000, v62
    v_fma_f32 v62, -v60, v60, v62
    v_add_f32 v60, s52, v60
    v_max_f32 v62, 0, v62
    v_cvt_pk_bf16_f32 v62, v62, v62
    v_and_b32 v62, s44, v62
    v_add_f32 v62, 0x3727c5ac, v62
    v_cvt_pk_bf16_f32 v62, v62, v62
    v_and_b32 v62, s44, v62
    v_sqrt_f32 v62, v62
    s_nop 0
    v_cvt_pk_bf16_f32 v60, v60, v62
    v_mul_f32 v66, 0x3b000000, v66
    v_mul_f32 v68, 0x3b000000, v68
    v_fma_f32 v68, -v66, v66, v68
    v_add_f32 v66, s54, v66
    v_max_f32 v68, 0, v68
    v_cvt_pk_bf16_f32 v68, v68, v68
    v_and_b32 v68, s44, v68
    v_add_f32 v68, 0x3727c5ac, v68
    v_cvt_pk_bf16_f32 v68, v68, v68
    v_and_b32 v68, s44, v68
    v_sqrt_f32 v68, v68
    s_nop 0
    v_cvt_pk_bf16_f32 v66, v66, v68
    v_readlane_b32 s56, v60, 63
    v_readlane_b32 s57, v66, 63
    s_and_b32 s58, s56, s44
    s_lshl_b32 s56, s56, 16
    s_and_b32 s59, s57, s44
    s_lshl_b32 s57, s57, 16
    v_rcp_f32 v72, s58
    v_rcp_f32 v74, s59
    v_mov_b32 v76, s56
    v_mov_b32 v78, s57
    v_subrev_f32 v76, s52, v76
    v_subrev_f32 v78, s54, v78
    v_pk_add_f32 v[44:45], v[44:45], v[76:77] op_sel_hi:[1,0] neg_lo:[0,1] neg_hi:[0,1]
    v_pk_add_f32 v[46:47], v[46:47], v[76:77] op_sel_hi:[1,0] neg_lo:[0,1] neg_hi:[0,1]
    v_pk_add_f32 v[48:49], v[48:49], v[76:77] op_sel_hi:[1,0] neg_lo:[0,1] neg_hi:[0,1]
    v_pk_add_f32 v[50:51], v[50:51], v[76:77] op_sel_hi:[1,0] neg_lo:[0,1] neg_hi:[0,1]
    v_pk_mul_f32 v[44:45], v[44:45], v[72:73] op_sel_hi:[1,0]
    v_pk_mul_f32 v[46:47], v[46:47], v[72:73] op_sel_hi:[1,0]
    v_pk_mul_f32 v[48:49], v[48:49], v[72:73] op_sel_hi:[1,0]
    v_pk_mul_f32 v[50:51], v[50:51], v[72:73] op_sel_hi:[1,0]
    v_pk_add_f32 v[52:53], v[52:53], v[78:79] op_sel_hi:[1,0] neg_lo:[0,1] neg_hi:[0,1]
    v_pk_add_f32 v[54:55], v[54:55], v[78:79] op_sel_hi:[1,0] neg_lo:[0,1] neg_hi:[0,1]
    v_pk_add_f32 v[56:57], v[56:57], v[78:79] op_sel_hi:[1,0] neg_lo:[0,1] neg_hi:[0,1]
    v_pk_add_f32 v[58:59], v[58:59], v[78:79] op_sel_hi:[1,0] neg_lo:[0,1] neg_hi:[0,1]
    v_pk_mul_f32 v[52:53], v[52:53], v[74:75] op_sel_hi:[1,0]
    v_pk_mul_f32 v[54:55], v[54:55], v[74:75] op_sel_hi:[1,0]
    v_pk_mul_f32 v[56:57], v[56:57], v[74:75] op_sel_hi:[1,0]
    v_pk_mul_f32 v[58:59], v[58:59], v[74:75] op_sel_hi:[1,0]
    v_cvt_pk_bf16_f32 v80, v44, v45
    v_cvt_pk_bf16_f32 v81, v46, v47
    v_cvt_pk_bf16_f32 v82, v48, v49
    v_cvt_pk_bf16_f32 v83, v50, v51
    v_cvt_pk_bf16_f32 v84, v52, v53
    v_cvt_pk_bf16_f32 v85, v54, v55
    v_cvt_pk_bf16_f32 v86, v56, v57
    v_cvt_pk_bf16_f32 v87, v58, v59
    s_sub_u32 s58, s39, 4
    s_lshl_b32 s59, s58, 10
    s_add_u32 s59, s59, 133952
    v_lshlrev_b32 v72, 4, v1
    v_add_u32 v72, s59, v72
    ds_write_b128 v72, v[80:83]
    ds_write_b128 v72, v[84:87] offset:4096
    v_mov_b32 v73, 86856
    v_mov_b32 v74, 1
    s_waitcnt lgkmcnt(0)
    s_mov_b64 exec, 1
    ds_add_u32 v73, v74
    s_mov_b64 exec, -1
    s_mov_b32 s47, 0
L_hs_5:
    s_add_u32 s47, s47, 1
    s_cmp_gt_u32 s47, 40000
    s_cbranch_scc1 L_hsx_6
    ds_read_b32 v75, v73
    s_waitcnt lgkmcnt(0)
    v_cmp_gt_u32 vcc, 4, v75
    s_cbranch_vccnz L_hs_5
L_hsx_6:
    v_lshlrev_b32 v72, 1, v32
    v_add_u32 v72, 133952, v72
    ds_read_u16 v44, v72 offset:0
    ds_read_u16 v45, v72 offset:1024
    ds_read_u16 v46, v72 offset:2048
    ds_read_u16 v47, v72 offset:3072
    ds_read_u16 v48, v72 offset:4096
    ds_read_u16 v49, v72 offset:5120
    ds_read_u16 v50, v72 offset:6144
    ds_read_u16 v51, v72 offset:7168
    ds_read_u16 v52, v72 offset:512
    ds_read_u16 v53, v72 offset:1536
    ds_read_u16 v54, v72 offset:2560
    ds_read_u16 v55, v72 offset:3584
    ds_read_u16 v56, v72 offset:4608
    ds_read_u16 v57, v72 offset:5632
    ds_read_u16 v58, v72 offset:6656
    ds_read_u16 v59, v72 offset:7680
    s_lshl_b32 s59, s38, 13
    s_add_u32 s59, s59, 4194304
    v_lshlrev_b32 v73, 4, v32
    v_add_u32 v73, s59, v73
    v_add_u32 v74, 4096, v73
    s_waitcnt lgkmcnt(8)
    v_lshl_or_b32 v60, v45, 16, v44
    v_lshl_or_b32 v61, v47, 16, v46
    v_lshl_or_b32 v62, v49, 16, v48
    v_lshl_or_b32 v63, v51, 16, v50
    v_min_u32 v60, -2, v60
    v_min_u32 v61, -2, v61
    v_min_u32 v62, -2, v62
    v_min_u32 v63, -2, v63
    global_store_dwordx4 v73, v[60:63], s[36:37] sc1
    s_waitcnt lgkmcnt(0)
    v_lshl_or_b32 v64, v53, 16, v52
    v_lshl_or_b32 v65, v55, 16, v54
    v_lshl_or_b32 v66, v57, 16, v56
    v_lshl_or_b32 v67, v59, 16, v58
    v_min_u32 v64, -2, v64
    v_min_u32 v65, -2, v65
    v_min_u32 v66, -2, v66
    v_min_u32 v67, -2, v67
    global_store_dwordx4 v74, v[64:67], s[36:37] sc1
    s_mul_i32 s40, s41, 0x9E3779B1
    s_add_u32 s40, s40, 0x632BE5AB
    s_waitcnt vmcnt(6)
    s_sub_u32 s56, s39, 5
    s_cmp_lt_u32 s56, 2
    s_cbranch_scc0 L_no_s0b
    s_lshl_b32 s56, s56, 2
    s_lshl_b32 s57, s38, 3
    s_add_u32 s56, s56, s57
    s_add_u32 s56, s56, 1507328
    v_mov_b32 v44, s56
    v_mov_b32 v45, s40
    s_mov_b64 exec, 1
    global_store_dword v44, v45, s[36:37] sc1
    s_mov_b64 exec, -1
L_no_s0b:
    v_lshlrev_b32 v12, 16, v12
    v_mul_f32 v44, 0xbfb8aa3b, v12
    v_lshlrev_b32 v13, 16, v13
    v_mul_f32 v45, 0xbfb8aa3b, v13
    v_lshlrev_b32 v14, 16, v14
    v_mul_f32 v46, 0xbfb8aa3b, v14
    v_lshlrev_b32 v15, 16, v15
    v_mul_f32 v47, 0xbfb8aa3b, v15
    v_exp_f32 v44, v44
    v_exp_f32 v45, v45
    v_exp_f32 v46, v46
    v_exp_f32 v47, v47
    v_add_f32 v44, 1.0, v44
    v_add_f32 v45, 1.0, v45
    v_add_f32 v46, 1.0, v46
    v_add_f32 v47, 1.0, v47
    v_rcp_f32 v44, v44
    v_rcp_f32 v45, v45
    v_rcp_f32 v46, v46
    v_rcp_f32 v47, v47
    v_mul_f32 v12, v12, v44
    v_mul_f32 v13, v13, v45
    v_mul_f32 v14, v14, v46
    v_mul_f32 v15, v15, v47
    v_cvt_pk_bf16_f32 v33, v12, v13
    v_cvt_pk_bf16_f32 v34, v14, v15
    v_lshlrev_b32 v12, 16, v33
    v_and_b32 v13, s44, v33
    v_lshlrev_b32 v14, 16, v34
    v_and_b32 v15, s44, v34
    s_cmp_eq_u32 s39, 7
    s_cbranch_scc1 L_mw2
    s_cmp_eq_u32 s39, 99
    s_cbranch_scc1 L_mw2
    s_waitcnt vmcnt(3)
    s_branch L_mw_done
L_mw2:
    s_waitcnt vmcnt(2)
L_mw_done:
    v_lshlrev_b32 v44, 16, v16
    v_and_b32 v45, s44, v16
    v_lshlrev_b32 v46, 16, v17
    v_and_b32 v47, s44, v17
    v_lshlrev_b32 v48, 16, v18
    v_and_b32 v49, s44, v18
    v_lshlrev_b32 v50, 16, v19
    v_and_b32 v51, s44, v19
    v_pk_mul_f32 v[52:53], v[44:45], v[12:13] op_sel_hi:[1,0]
    v_pk_mul_f32 v[54:55], v[46:47], v[12:13] op_sel_hi:[1,0]
    v_pk_mul_f32 v[56:57], v[48:49], v[12:13] op_sel_hi:[1,0]
    v_pk_mul_f32 v[58:59], v[50:51], v[12:13] op_sel_hi:[1,0]
    v_lshlrev_b32 v44, 16, v20
    v_and_b32 v45, s44, v20
    v_lshlrev_b32 v46, 16, v21
    v_and_b32 v47, s44, v21
    v_lshlrev_b32 v48, 16, v22
    v_and_b32 v49, s44, v22
    v_lshlrev_b32 v50, 16, v23
    v_and_b32 v51, s44, v23
    v_pk_fma_f32 v[52:53], v[44:45], v[12:13], v[52:53] op_sel:[0,1,0] op_sel_hi:[1,1,1]
    v_pk_fma_f32 v[54:55], v[46:47], v[12:13], v[54:55] op_sel:[0,1,0] op_sel_hi:[1,1,1]
    v_pk_fma_f32 v[56:57], v[48:49], v[12:13], v[56:57] op_sel:[0,1,0] op_sel_hi:[1,1,1]
    v_pk_fma_f32 v[58:59], v[50:51], v[12:13], v[58:59] op_sel:[0,1,0] op_sel_hi:[1,1,1]
    v_lshlrev_b32 v44, 16, v24
    v_and_b32 v45, s44, v24
    v_lshlrev_b32 v46, 16, v25
    v_and_b32 v47, s44, v25
    v_lshlrev_b32 v48, 16, v26
    v_and_b32 v49, s44, v26
    v_lshlrev_b32 v50, 16, v27
    v_and_b32 v51, s44, v27
    v_pk_fma_f32 v[52:53], v[44:45], v[14:15], v[52:53] op_sel_hi:[1,0,1]
    v_pk_fma_f32 v[54:55], v[46:47], v[14:15], v[54:55] op_sel_hi:[1,0,1]
    v_pk_fma_f32 v[56:57], v[48:49], v[14:15], v[56:57] op_sel_hi:[1,0,1]
    v_pk_fma_f32 v[58:59], v[50:51], v[14:15], v[58:59] op_sel_hi:[1,0,1]
    v_lshlrev_b32 v44, 16, v28
    v_and_b32 v45, s44, v28
    v_lshlrev_b32 v46, 16, v29
    v_and_b32 v47, s44, v29
    v_lshlrev_b32 v48, 16, v30
    v_and_b32 v49, s44, v30
    v_lshlrev_b32 v50, 16, v31
    v_and_b32 v51, s44, v31
    v_pk_fma_f32 v[52:53], v[44:45], v[14:15], v[52:53] op_sel:[0,1,0] op_sel_hi:[1,1,1]
    v_pk_fma_f32 v[54:55], v[46:47], v[14:15], v[54:55] op_sel:[0,1,0] op_sel_hi:[1,1,1]
    v_pk_fma_f32 v[56:57], v[48:49], v[14:15], v[56:57] op_sel:[0,1,0] op_sel_hi:[1,1,1]
    v_pk_fma_f32 v[58:59], v[50:51], v[14:15], v[58:59] op_sel:[0,1,0] op_sel_hi:[1,1,1]
    s_nop 0
    v_permlane32_swap_b32 v52, v56
    v_permlane32_swap_b32 v53, v57
    v_permlane32_swap_b32 v54, v58
    v_permlane32_swap_b32 v55, v59
    v_add_f32 v52, v52, v56
    v_add_f32 v53, v53, v57
    v_add_f32 v54, v54, v58
    v_add_f32 v55, v55, v59
    s_nop 0
    v_permlane16_swap_b32 v52, v54
    v_permlane16_swap_b32 v53, v55
    v_add_f32 v52, v52, v54
    v_add_f32 v53, v53, v55
    s_nop 0
    v_add_f32_dpp v52, v52, v52 row_ror:8 row_mask:0xf bank_mask:0xf
    v_add_f32_dpp v53, v53, v53 row_ror:8 row_mask:0xf bank_mask:0xf
    v_and_b32 v33, 7, v1
    v_lshlrev_b32 v33, 5, v33
    v_lshrrev_b32 v34, 5, v1
    v_lshl_add_u32 v33, v34, 4, v33
    v_bfe_u32 v34, v1, 4, 1
    v_lshl_add_u32 v33, v34, 3, v33
    s_lshl_b32 s52, s58, 8
    s_add_u32 s52, s52, 87104
    v_add_u32 v33, s52, v33
    ds_write_b64 v33, v[52:53]
    v_mov_b32 v34, 86848
    v_mov_b32 v35, 1
    s_waitcnt lgkmcnt(0)
    s_mov_b64 exec, 1
    ds_add_rtn_u32 v36, v34, v35
    s_waitcnt lgkmcnt(0)
    v_readfirstlane_b32 s52, v36
    s_mov_b64 exec, -1
    s_cmp_eq_u32 s52, 3
    s_cbranch_scc0 L_mod_done
    s_cmp_lt_u32 s38, 192
    s_cbranch_scc0 L_mod_done
    v_lshlrev_b32 v33, 3, v1
    v_add_u32 v34, 87104, v33
    s_mov_b32 exec_lo, -1
    s_mov_b32 exec_hi, 0
    ds_read_b64 v[44:45], v34
    ds_read_b64 v[46:47], v34 offset:256
    ds_read_b64 v[48:49], v34 offset:512
    ds_read_b64 v[50:51], v34 offset:768
    s_and_b32 s52, s38, 3
    s_mul_i32 s52, s52, 24576
    s_lshr_b32 s53, s38, 2
    s_lshl_b32 s53, s53, 9
    s_add_u32 s52, s52, s53
    s_add_u32 s52, s52, 1310720
    v_lshlrev_b32 v33, 4, v1
    v_add_u32 v33, s52, v33
    s_waitcnt lgkmcnt(0)
    v_pk_add_f32 v[44:45], v[44:45], v[46:47]
    v_pk_add_f32 v[48:49], v[48:49], v[50:51]
    v_pk_add_f32 v[44:45], v[44:45], v[48:49]
    v_mov_b32 v46, s40
    v_mov_b32 v47, 0
    global_store_dwordx4 v33, v[44:47], s[36:37] sc1
    s_mov_b64 exec, -1
L_mod_done:
    s_setprio 0
L_b2:
    s_barrier
    v_lshrrev_b32 v98, 1, v0
    v_lshlrev_b32 v98, 13, v98
    v_and_b32 v99, 1, v0
    v_lshl_add_u32 v98, v99, 4, v98
    s_lshl_b32 s52, s38, 5
    s_add_u32 s52, s52, 4194304
    v_add_u32 v98, s52, v98
    v_min_u32 v97, 11, v1
    v_and_b32 v96, 3, v97
    v_mul_u32_u24 v96, 24576, v96
    v_lshrrev_b32 v97, 2, v97
    v_lshl_add_u32 v97, v97, 12, v96
    s_lshl_b32 s52, s38, 4
    s_add_u32 s52, s52, 1310720
    v_add_u32 v97, s52, v97
    v_mov_b32 v99, v97
    global_load_dwordx4 v[104:107], v99, s[36:37] sc1
    global_load_dwordx4 v[100:103], v98, s[36:37] sc1
    ds_read_u16 v64, v238
    ds_read_u16 v65, v239
    ds_read_u16 v66, v240
    ds_read_u16 v67, v241
    ds_read_u16 v68, v242
    ds_read_u16 v69, v243
    ds_read_u16 v70, v244
    ds_read_u16 v71, v245
    ds_read_u16 v72, v246
    v_and_b32 v44, 255, v0
    s_lshr_b32 s52, s39, 2
    s_mul_i32 s52, s52, 8576
    s_add_u32 s52, s52, 69696
    v_lshlrev_b32 v45, 4, v44
    v_add_u32 v45, s52, v45
    v_mov_b32 v93, 0
    v_mov_b32 v94, 0
    v_mov_b32 v95, 0
    v_mov_b32 v116, 0
    v_mov_b32 v117, 0
    s_waitcnt lgkmcnt(0)
    v_lshl_or_b32 v84, v65, 16, v64
    v_lshl_or_b32 v85, v67, 16, v66
    v_lshl_or_b32 v86, v69, 16, v68
    v_lshl_or_b32 v87, v71, 16, v70
    v_alignbit_b32 v88, v85, v84, 16
    v_alignbit_b32 v89, v86, v85, 16
    v_alignbit_b32 v90, v87, v86, 16
    v_alignbit_b32 v91, v72, v87, 16
    ds_write_b128 v45, v[84:87]
    ds_write_b128 v45, v[88:91] offset:4288
    v_cmp_eq_u32 vcc, 255, v44
    v_mov_b32 v92, v72
    v_mov_b32 v118, 0
    v_mov_b32 v119, 0
    s_and_saveexec_b64 s[48:49], vcc
    s_cbranch_execz L_notail
    ds_write_b128 v45, v[92:95] offset:16
    ds_write_b128 v45, v[116:119] offset:32
    ds_write_b128 v45, v[116:119] offset:4304
    ds_write_b128 v45, v[116:119] offset:4320
L_notail:
    s_mov_b64 exec, s[48:49]
    s_cmp_lt_u32 s39, 2
    s_cbranch_scc0 L_nopad
    s_mul_i32 s52, s39, 4672
    s_add_u32 s52, s52, 64
    v_lshlrev_b32 v45, 3, v1
    v_add_u32 v45, s52, v45
    ds_write_b64 v45, v[94:95]
L_nopad:
    s_waitcnt lgkmcnt(0)
    s_barrier
    s_cmp_lt_u32 s39, 4
    s_cbranch_scc0 L_s1_poll
    s_lshr_b32 s58, s39, 1
    s_and_b32 s59, s39, 1
    v_and_b32 v44, 15, v1
    v_lshrrev_b32 v45, 4, v1
    v_and_b32 v46, 1, v44
    v_add_u32 v47, v44, v46
    v_lshlrev_b32 v48, 3, v45
    v_sub_u32 v47, v48, v47
    v_lshlrev_b32 v47, 1, v47
    v_mul_u32_u24 v46, 4288, v46
    s_mul_i32 s60, s58, 8576
    s_lshl_b32 s61, s59, 8
    s_sub_u32 s60, s60, s61
    s_add_u32 s60, s60, 73248
    v_add3_u32 v232, v47, v46, s60
    v_subrev_u32 v233, 1024, v232
    v_subrev_u32 v234, 2048, v232
    v_subrev_u32 v235, 3072, v232
    s_mul_i32 s60, s58, 4672
    s_sub_u32 s60, s60, s61
    s_add_u32 s60, s60, 544
    v_lshlrev_b32 v46, 5, v44
    v_lshl_add_u32 v46, v45, 4, v46
    v_add_u32 v236, s60, v46
    ds_read2_b32 v[224:225], v235 offset0:0 offset1:1
    ds_read2_b32 v[226:227], v235 offset0:2 offset1:3
    ds_read2_b32 v[220:221], v235 offset0:128 offset1:129
    ds_read2_b32 v[222:223], v235 offset0:130 offset1:131
    ds_read2_b32 v[216:217], v234 offset0:0 offset1:1
    ds_read2_b32 v[218:219], v234 offset0:2 offset1:3
    ds_read2_b32 v[212:213], v234 offset0:128 offset1:129
    ds_read2_b32 v[214:215], v234 offset0:130 offset1:131
    v_mov_b32 v64, 0
    v_mov_b32 v65, 0
    v_mov_b32 v66, 0
    v_mov_b32 v67, 0
    v_mov_b32 v68, 0
    v_mov_b32 v69, 0
    v_mov_b32 v70, 0
    v_mov_b32 v71, 0
    v_mov_b32 v72, 0
    v_mov_b32 v73, 0
    v_mov_b32 v74, 0
    v_mov_b32 v75, 0
    v_mov_b32 v76, 0
    v_mov_b32 v77, 0
    v_mov_b32 v78, 0
    v_mov_b32 v79, 0
    s_waitcnt lgkmcnt(0)
    ds_read2_b32 v[208:209], v233 offset0:0 offset1:1
    ds_read2_b32 v[210:211], v233 offset0:2 offset1:3
    ds_read2_b32 v[204:205], v233 offset0:128 offset1:129
    ds_read2_b32 v[206:207], v233 offset0:130 offset1:131
    ds_read2_b32 v[200:201], v232 offset0:0 offset1:1
    ds_read2_b32 v[202:203], v232 offset0:2 offset1:3
    ds_read2_b32 v[196:197], v232 offset0:128 offset1:129
    ds_read2_b32 v[198:199], v232 offset0:130 offset1:131
    v_mov_b32 v80, 0
    v_mov_b32 v81, 0
    v_mov_b32 v82, 0
    v_mov_b32 v83, 0
    v_mov_b32 v84, 0
    v_mov_b32 v85, 0
    v_mov_b32 v86, 0
    v_mov_b32 v87, 0
    v_mov_b32 v88, 0
    v_mov_b32 v89, 0
    v_mov_b32 v90, 0
    v_mov_b32 v91, 0
    v_mov_b32 v92, 0
    v_mov_b32 v93, 0
    v_mov_b32 v94, 0
    v_mov_b32 v95, 0
    v_subrev_u32 v232, 64, v232
    v_subrev_u32 v233, 64, v233
    v_subrev_u32 v234, 64, v234
    v_subrev_u32 v235, 64, v235
L_s1_poll:
    s_mov_b32 s47, 0
    s_waitcnt vmcnt(1)
L_s1m_7:
    v_cmp_ne_u32 vcc, s40, v106
    s_cbranch_vccz L_s1mx_8
    s_add_u32 s47, s47, 1
    s_cmp_gt_u32 s47, 40000
    s_cbranch_scc1 L_s1mx_8
    global_load_dwordx4 v[104:107], v99, s[36:37] sc1
    s_waitcnt vmcnt(0)
    s_branch L_s1m_7
L_s1mx_8:
    v_add_f32_dpp v104, v104, v104 quad_perm:[1,0,3,2] row_mask:0xf bank_mask:0xf
    v_add_f32_dpp v105, v105, v105 quad_perm:[1,0,3,2] row_mask:0xf bank_mask:0xf
    s_nop 0
    v_add_f32_dpp v104, v104, v104 quad_perm:[2,3,0,1] row_mask:0xf bank_mask:0xf
    v_add_f32_dpp v105, v105, v105 quad_perm:[2,3,0,1] row_mask:0xf bank_mask:0xf
    v_cvt_pk_bf16_f32 v104, v104, v105
    s_nop 0
    v_readlane_b32 s60, v104, 0
    v_readlane_b32 s61, v104, 4
    v_readlane_b32 s62, v104, 8
    v_and_b32 v46, 1, v0
    v_cmp_eq_u32 vcc, 1, v46
    v_mov_b32 v47, s60
    v_mov_b32 v48, s61
    v_lshlrev_b32 v49, 16, v47
    v_and_b32 v47, s44, v47
    v_lshlrev_b32 v50, 16, v48
    v_and_b32 v48, s44, v48
    v_cndmask_b32 v52, v49, v47, vcc
    v_cndmask_b32 v50, v50, v48, vcc
    v_add_f32 v50, 1.0, v50
    v_cvt_pk_bf16_f32 v50, v50, v50
    v_and_b32 v50, s44, v50
    s_lshl_b32 s56, s62, 16
    s_and_b32 s57, s62, s44
    v_lshrrev_b32 v44, 1, v0
    v_lshlrev_b32 v44, 4, v44
    v_mul_u32_u24 v45, 4672, v46
    v_add_u32 v44, v44, v45
    v_add_u32 v44, 576, v44
    s_mov_b32 s47, 0
    s_branch L_s1c_11
L_s1_9:
    s_add_u32 s47, s47, 1
    s_cmp_gt_u32 s47, 40000
    s_cbranch_scc1 L_s1x_10
    global_load_dwordx4 v[100:103], v98, s[36:37] sc1
L_s1c_11:
    s_waitcnt vmcnt(0)
    v_max_u32 v46, v100, v101
    v_max3_u32 v46, v46, v102, v103
    v_cmp_eq_u32 vcc, -1, v46
    s_nop 0
    s_and_b64 exec, exec, vcc
    s_cbranch_execnz L_s1_9
L_s1x_10:
    s_mov_b64 exec, -1
    v_lshlrev_b32 v110, 16, v100
    v_and_b32 v111, s44, v100
    v_lshlrev_b32 v112, 16, v101
    v_and_b32 v113, s44, v101
    v_lshlrev_b32 v114, 16, v102
    v_and_b32 v115, s44, v102
    v_lshlrev_b32 v116, 16, v103
    v_and_b32 v117, s44, v103
    v_pk_fma_f32 v[110:111], v[110:111], v[50:51], v[52:53] op_sel_hi:[1,0,0]
    v_pk_fma_f32 v[112:113], v[112:113], v[50:51], v[52:53] op_sel_hi:[1,0,0]
    v_pk_fma_f32 v[114:115], v[114:115], v[50:51], v[52:53] op_sel_hi:[1,0,0]
    v_pk_fma_f32 v[116:117], v[116:117], v[50:51], v[52:53] op_sel_hi:[1,0,0]
    v_cvt_pk_bf16_f32 v100, v110, v111
    v_cvt_pk_bf16_f32 v101, v112, v113
    v_cvt_pk_bf16_f32 v102, v114, v115
    v_cvt_pk_bf16_f32 v103, v116, v117
    ds_write_b128 v44, v[100:103]
    s_waitcnt lgkmcnt(0)
    s_barrier
    s_cmp_lt_u32 s39, 4
    s_cbranch_scc0 L_helper2
    ds_read_b128 v[128:131], v236 offset:0
    ds_read_b128 v[132:135], v236 offset:512
    ds_read_b128 v[136:139], v236 offset:1024
    ds_read_b128 v[140:143], v236 offset:1536
    ds_read_b128 v[144:147], v236 offset:2048
    ds_read_b128 v[148:151], v236 offset:2560
    ds_read_b128 v[152:155], v236 offset:3072
    ds_read_b128 v[156:159], v236 offset:3584
    v_subrev_u32 v236, 64, v236
    s_mov_b32 s60, 2
L_conv:
    s_waitcnt lgkmcnt(7)
    v_mfma_f32_16x16x32_bf16 v[92:95], v[224:227], v[128:131], v[92:95]
    ds_read2_b32 v[224:225], v235 offset0:0 offset1:1
    s_waitcnt lgkmcnt(7)
    v_mfma_f32_16x16x32_bf16 v[88:91], v[220:223], v[128:131], v[88:91]
    ds_read2_b32 v[226:227], v235 offset0:2 offset1:3
    v_mfma_f32_16x16x32_bf16 v[92:95], v[220:223], v[132:135], v[92:95]
    ds_read2_b32 v[220:221], v235 offset0:128 offset1:129
    s_waitcnt lgkmcnt(8)
    v_mfma_f32_16x16x32_bf16 v[84:87], v[216:219], v[128:131], v[84:87]
    ds_read2_b32 v[222:223], v235 offset0:130 offset1:131
    v_mfma_f32_16x16x32_bf16 v[88:91], v[216:219], v[132:135], v[88:91]
    v_subrev_u32 v235, 64, v235
    v_mfma_f32_16x16x32_bf16 v[92:95], v[216:219], v[136:139], v[92:95]
    ds_read2_b32 v[216:217], v234 offset0:0 offset1:1
    s_waitcnt lgkmcnt(9)
    v_mfma_f32_16x16x32_bf16 v[80:83], v[212:215], v[128:131], v[80:83]
    ds_read2_b32 v[218:219], v234 offset0:2 offset1:3
    v_mfma_f32_16x16x32_bf16 v[84:87], v[212:215], v[132:135], v[84:87]
    ds_read_b128 v[160:163], v236 offset:0
    v_mfma_f32_16x16x32_bf16 v[88:91], v[212:215], v[136:139], v[88:91]
    ds_read_b128 v[164:167], v236 offset:512
    v_mfma_f32_16x16x32_bf16 v[92:95], v[212:215], v[140:143], v[92:95]
    ds_read2_b32 v[212:213], v234 offset0:128 offset1:129
    s_waitcnt lgkmcnt(9)
    v_mfma_f32_16x16x32_bf16 v[76:79], v[208:211], v[128:131], v[76:79]
    ds_read2_b32 v[214:215], v234 offset0:130 offset1:131
    v_mfma_f32_16x16x32_bf16 v[80:83], v[208:211], v[132:135], v[80:83]
    v_subrev_u32 v234, 64, v234
    v_mfma_f32_16x16x32_bf16 v[84:87], v[208:211], v[136:139], v[84:87]
    ds_read_b128 v[168:171], v236 offset:1024
    v_mfma_f32_16x16x32_bf16 v[88:91], v[208:211], v[140:143], v[88:91]
    ds_read_b128 v[172:175], v236 offset:1536
    v_mfma_f32_16x16x32_bf16 v[92:95], v[208:211], v[144:147], v[92:95]
    ds_read2_b32 v[208:209], v233 offset0:0 offset1:1
    v_mfma_f32_16x16x32_bf16 v[72:75], v[204:207], v[128:131], v[72:75]
    ds_read2_b32 v[210:211], v233 offset0:2 offset1:3
    v_mfma_f32_16x16x32_bf16 v[76:79], v[204:207], v[132:135], v[76:79]
    ds_read_b128 v[176:179], v236 offset:2048
    v_mfma_f32_16x16x32_bf16 v[80:83], v[204:207], v[136:139], v[80:83]
    ds_read_b128 v[180:183], v236 offset:2560
    v_mfma_f32_16x16x32_bf16 v[84:87], v[204:207], v[140:143], v[84:87]
    v_mfma_f32_16x16x32_bf16 v[88:91], v[204:207], v[144:147], v[88:91]
    v_mfma_f32_16x16x32_bf16 v[92:95], v[204:207], v[148:151], v[92:95]
    ds_read2_b32 v[204:205], v233 offset0:128 offset1:129
    v_mfma_f32_16x16x32_bf16 v[68:71], v[200:203], v[128:131], v[68:71]
    ds_read2_b32 v[206:207], v233 offset0:130 offset1:131
    v_mfma_f32_16x16x32_bf16 v[72:75], v[200:203], v[132:135], v[72:75]
    v_subrev_u32 v233, 64, v233
    v_mfma_f32_16x16x32_bf16 v[76:79], v[200:203], v[136:139], v[76:79]
    ds_read_b128 v[184:187], v236 offset:3072
    v_mfma_f32_16x16x32_bf16 v[80:83], v[200:203], v[140:143], v[80:83]
    ds_read_b128 v[188:191], v236 offset:3584
    v_mfma_f32_16x16x32_bf16 v[84:87], v[200:203], v[144:147], v[84:87]
    v_subrev_u32 v236, 64, v236
    v_mfma_f32_16x16x32_bf16 v[88:91], v[200:203], v[148:151], v[88:91]
    v_mfma_f32_16x16x32_bf16 v[92:95], v[200:203], v[152:155], v[92:95]
    ds_read2_b32 v[200:201], v232 offset0:0 offset1:1
    v_mfma_f32_16x16x32_bf16 v[64:67], v[196:199], v[128:131], v[64:67]
    ds_read2_b32 v[202:203], v232 offset0:2 offset1:3
    v_mfma_f32_16x16x32_bf16 v[68:71], v[196:199], v[132:135], v[68:71]
    v_mfma_f32_16x16x32_bf16 v[72:75], v[196:199], v[136:139], v[72:75]
    v_mfma_f32_16x16x32_bf16 v[76:79], v[196:199], v[140:143], v[76:79]
    v_mfma_f32_16x16x32_bf16 v[80:83], v[196:199], v[144:147], v[80:83]
    v_mfma_f32_16x16x32_bf16 v[84:87], v[196:199], v[148:151], v[84:87]
    v_mfma_f32_16x16x32_bf16 v[88:91], v[196:199], v[152:155], v[88:91]
    v_mfma_f32_16x16x32_bf16 v[92:95], v[196:199], v[156:159], v[92:95]
    ds_read2_b32 v[196:197], v232 offset0:128 offset1:129
    ds_read2_b32 v[198:199], v232 offset0:130 offset1:131
    v_subrev_u32 v232, 64, v232
    s_waitcnt lgkmcnt(7)
    v_mfma_f32_16x16x32_bf16 v[92:95], v[224:227], v[160:163], v[92:95]
    ds_read2_b32 v[224:225], v235 offset0:0 offset1:1
    s_waitcnt lgkmcnt(7)
    v_mfma_f32_16x16x32_bf16 v[88:91], v[220:223], v[160:163], v[88:91]
    ds_read2_b32 v[226:227], v235 offset0:2 offset1:3
    v_mfma_f32_16x16x32_bf16 v[92:95], v[220:223], v[164:167], v[92:95]
    ds_read2_b32 v[220:221], v235 offset0:128 offset1:129
    s_waitcnt lgkmcnt(8)
    v_mfma_f32_16x16x32_bf16 v[84:87], v[216:219], v[160:163], v[84:87]
    ds_read2_b32 v[222:223], v235 offset0:130 offset1:131
    v_mfma_f32_16x16x32_bf16 v[88:91], v[216:219], v[164:167], v[88:91]
    v_subrev_u32 v235, 64, v235
    v_mfma_f32_16x16x32_bf16 v[92:95], v[216:219], v[168:171], v[92:95]
    ds_read2_b32 v[216:217], v234 offset0:0 offset1:1
    s_waitcnt lgkmcnt(9)
    v_mfma_f32_16x16x32_bf16 v[80:83], v[212:215], v[160:163], v[80:83]
    ds_read2_b32 v[218:219], v234 offset0:2 offset1:3
    v_mfma_f32_16x16x32_bf16 v[84:87], v[212:215], v[164:167], v[84:87]
    ds_read_b128 v[128:131], v236 offset:0
    v_mfma_f32_16x16x32_bf16 v[88:91], v[212:215], v[168:171], v[88:91]
    ds_read_b128 v[132:135], v236 offset:512
    v_mfma_f32_16x16x32_bf16 v[92:95], v[212:215], v[172:175], v[92:95]
    ds_read2_b32 v[212:213], v234 offset0:128 offset1:129
    s_waitcnt lgkmcnt(9)
    v_mfma_f32_16x16x32_bf16 v[76:79], v[208:211], v[160:163], v[76:79]
    ds_read2_b32 v[214:215], v234 offset0:130 offset1:131
    v_mfma_f32_16x16x32_bf16 v[80:83], v[208:211], v[164:167], v[80:83]
    v_subrev_u32 v234, 64, v234
    v_mfma_f32_16x16x32_bf16 v[84:87], v[208:211], v[168:171], v[84:87]
    ds_read_b128 v[136:139], v236 offset:1024
    v_mfma_f32_16x16x32_bf16 v[88:91], v[208:211], v[172:175], v[88:91]
    ds_read_b128 v[140:143], v236 offset:1536
    v_mfma_f32_16x16x32_bf16 v[92:95], v[208:211], v[176:179], v[92:95]
    ds_read2_b32 v[208:209], v233 offset0:0 offset1:1
    v_mfma_f32_16x16x32_bf16 v[72:75], v[204:207], v[160:163], v[72:75]
    ds_read2_b32 v[210:211], v233 offset0:2 offset1:3
    v_mfma_f32_16x16x32_bf16 v[76:79], v[204:207], v[164:167], v[76:79]
    ds_read_b128 v[144:147], v236 offset:2048
    v_mfma_f32_16x16x32_bf16 v[80:83], v[204:207], v[168:171], v[80:83]
    ds_read_b128 v[148:151], v236 offset:2560
    v_mfma_f32_16x16x32_bf16 v[84:87], v[204:207], v[172:175], v[84:87]
    v_mfma_f32_16x16x32_bf16 v[88:91], v[204:207], v[176:179], v[88:91]
    v_mfma_f32_16x16x32_bf16 v[92:95], v[204:207], v[180:183], v[92:95]
    ds_read2_b32 v[204:205], v233 offset0:128 offset1:129
    v_mfma_f32_16x16x32_bf16 v[68:71], v[200:203], v[160:163], v[68:71]
    ds_read2_b32 v[206:207], v233 offset0:130 offset1:131
    v_mfma_f32_16x16x32_bf16 v[72:75], v[200:203], v[164:167], v[72:75]
    v_subrev_u32 v233, 64, v233
    v_mfma_f32_16x16x32_bf16 v[76:79], v[200:203], v[168:171], v[76:79]
    ds_read_b128 v[152:155], v236 offset:3072
    v_mfma_f32_16x16x32_bf16 v[80:83], v[200:203], v[172:175], v[80:83]
    ds_read_b128 v[156:159], v236 offset:3584
    v_mfma_f32_16x16x32_bf16 v[84:87], v[200:203], v[176:179], v[84:87]
    v_subrev_u32 v236, 64, v236
    v_mfma_f32_16x16x32_bf16 v[88:91], v[200:203], v[180:183], v[88:91]
    v_mfma_f32_16x16x32_bf16 v[92:95], v[200:203], v[184:187], v[92:95]
    ds_read2_b32 v[200:201], v232 offset0:0 offset1:1
    v_mfma_f32_16x16x32_bf16 v[64:67], v[196:199], v[160:163], v[64:67]
    ds_read2_b32 v[202:203], v232 offset0:2 offset1:3
    v_mfma_f32_16x16x32_bf16 v[68:71], v[196:199], v[164:167], v[68:71]
    v_mfma_f32_16x16x32_bf16 v[72:75], v[196:199], v[168:171], v[72:75]
    v_mfma_f32_16x16x32_bf16 v[76:79], v[196:199], v[172:175], v[76:79]
    v_mfma_f32_16x16x32_bf16 v[80:83], v[196:199], v[176:179], v[80:83]
    v_mfma_f32_16x16x32_bf16 v[84:87], v[196:199], v[180:183], v[84:87]
    v_mfma_f32_16x16x32_bf16 v[88:91], v[196:199], v[184:187], v[88:91]
    v_mfma_f32_16x16x32_bf16 v[92:95], v[196:199], v[188:191], v[92:95]
    ds_read2_b32 v[196:197], v232 offset0:128 offset1:129
    ds_read2_b32 v[198:199], v232 offset0:130 offset1:131
    v_subrev_u32 v232, 64, v232
    s_sub_u32 s60, s60, 1
    s_cmp_lg_u32 s60, 0
    s_cbranch_scc1 L_conv
    s_lshl_b32 s61, s39, 13
    s_add_u32 s61, s61, 9472
    v_lshlrev_b32 v44, 4, v1
    v_add_u32 v45, s61, v44
    ds_write_b128 v45, v[64:67] offset:0
    ds_write_b128 v45, v[68:71] offset:1024
    ds_write_b128 v45, v[72:75] offset:2048
    ds_write_b128 v45, v[76:79] offset:3072
    ds_write_b128 v45, v[80:83] offset:4096
    ds_write_b128 v45, v[84:87] offset:5120
    ds_write_b128 v45, v[88:91] offset:6144
    ds_write_b128 v45, v[92:95] offset:7168
    s_lshl_b32 s61, s39, 11
    s_add_u32 s60, s61, 9472
    v_add_u32 v58, s60, v44
    v_and_b32 v44, 15, v1
    v_lshrrev_b32 v45, 4, v1
    v_mov_b32 v54, s56
    v_mov_b32 v55, s57
    s_lshl_b32 s60, s38, 13
    s_add_u32 s60, s60, s61
    s_add_u32 s60, s60, 2097152
    v_lshlrev_b32 v52, 6, v44
    v_lshl_add_u32 v52, v45, 4, v52
    v_add_u32 v52, s60, v52
    s_waitcnt lgkmcnt(0)
    s_barrier
    ds_read_b128 v[96:99], v58 offset:0
    ds_read_b128 v[100:103], v58 offset:8192
    ds_read_b128 v[104:107], v58 offset:1024
    ds_read_b128 v[108:111], v58 offset:9216
    ds_read_b128 v[112:115], v58 offset:16384
    ds_read_b128 v[116:119], v58 offset:24576
    ds_read_b128 v[120:123], v58 offset:17408
    ds_read_b128 v[124:127], v58 offset:25600
    s_waitcnt lgkmcnt(6)
    v_pk_add_f32 v[96:97], v[96:97], v[100:101]
    v_pk_add_f32 v[98:99], v[98:99], v[102:103]
    v_pk_mul_f32 v[96:97], v[96:97], v[54:55] op_sel_hi:[1,0]
    v_pk_mul_f32 v[98:99], v[98:99], v[54:55] op_sel_hi:[1,0]
    v_cvt_pk_bf16_f32 v44, v96, v97
    v_cvt_pk_bf16_f32 v45, v98, v99
    v_min_u32 v44, -2, v44
    v_min_u32 v45, -2, v45
    s_waitcnt lgkmcnt(4)
    v_pk_add_f32 v[104:105], v[104:105], v[108:109]
    v_pk_add_f32 v[106:107], v[106:107], v[110:111]
    v_pk_mul_f32 v[104:105], v[104:105], v[54:55] op_sel_hi:[1,0]
    v_pk_mul_f32 v[106:107], v[106:107], v[54:55] op_sel_hi:[1,0]
    v_cvt_pk_bf16_f32 v48, v104, v105
    v_cvt_pk_bf16_f32 v49, v106, v107
    v_min_u32 v48, -2, v48
    v_min_u32 v49, -2, v49
    s_waitcnt lgkmcnt(2)
    v_pk_add_f32 v[112:113], v[112:113], v[116:117]
    v_pk_add_f32 v[114:115], v[114:115], v[118:119]
    v_pk_mul_f32 v[112:113], v[112:113], v[54:55] op_sel:[0,1] op_sel_hi:[1,1]
    v_pk_mul_f32 v[114:115], v[114:115], v[54:55] op_sel:[0,1] op_sel_hi:[1,1]
    v_cvt_pk_bf16_f32 v46, v112, v113
    v_cvt_pk_bf16_f32 v47, v114, v115
    v_min_u32 v46, -2, v46
    v_min_u32 v47, -2, v47
    s_waitcnt lgkmcnt(0)
    v_pk_add_f32 v[120:121], v[120:121], v[124:125]
    v_pk_add_f32 v[122:123], v[122:123], v[126:127]
    v_pk_mul_f32 v[120:121], v[120:121], v[54:55] op_sel:[0,1] op_sel_hi:[1,1]
    v_pk_mul_f32 v[122:123], v[122:123], v[54:55] op_sel:[0,1] op_sel_hi:[1,1]
    v_cvt_pk_bf16_f32 v50, v120, v121
    v_cvt_pk_bf16_f32 v51, v122, v123
    v_min_u32 v50, -2, v50
    v_min_u32 v51, -2, v51
    v_permlane16_swap_b32 v44, v46
    v_permlane16_swap_b32 v45, v47
    global_store_dwordx4 v52, v[44:47], s[36:37] offset:0 sc1
    v_permlane16_swap_b32 v48, v50
    v_permlane16_swap_b32 v49, v51
    global_store_dwordx4 v52, v[48:51], s[36:37] offset:1024 sc1
    s_branch L_tst
L_helper2:
L_noepoch:
    s_mov_b32 s68, 0
    s_cmp_lt_u32 s38, 172
    s_cselect_b32 s68, 1, 0
    s_cmp_ge_u32 s38, 192
    s_cselect_b32 s58, 2, 0
    s_cmp_lt_u32 s38, 224
    s_cselect_b32 s58, s58, 0
    s_or_b32 s68, s68, s58
    v_mov_b32 v148, 0
    v_mov_b32 v149, 0
    s_cmp_eq_u32 s39, 7
    s_cbranch_scc0 L_s0b_done
    v_lshlrev_b32 v44, 4, v1
    v_add_u32 v44, 1507328, v44
    s_mov_b32 s47, 0
L_s0b_12:
    s_add_u32 s47, s47, 1
    s_cmp_gt_u32 s47, 40000
    s_cbranch_scc1 L_s0bx_13
    global_load_dwordx4 v[48:51], v44, s[36:37] sc1
    global_load_dwordx4 v[52:55], v44, s[36:37] offset:1024 sc1
    s_waitcnt vmcnt(0)
    v_xor_b32 v48, s40, v48
    v_xor_b32 v49, s40, v49
    v_xor_b32 v50, s40, v50
    v_xor_b32 v51, s40, v51
    v_xor_b32 v52, s40, v52
    v_xor_b32 v53, s40, v53
    v_xor_b32 v54, s40, v54
    v_xor_b32 v55, s40, v55
    v_or3_b32 v48, v48, v49, v50
    v_or3_b32 v51, v51, v52, v53
    v_or3_b32 v48, v48, v54, v55
    v_or_b32 v48, v48, v51
    v_cmp_ne_u32 vcc, 0, v48
    s_cbranch_vccnz L_s0b_12
L_s0bx_13:
L_s0b_done:
    s_sub_u32 s58, s39, 4
    s_cmp_eq_u32 s68, 2
    s_cbranch_scc0 L_w_notdown
    s_mul_i32 s59, s58, 352
    v_lshrrev_b32 v46, 1, v1
    v_add_u32 v46, s59, v46
    v_and_b32 v47, 1, v1
    v_lshlrev_b32 v47, 4, v47
    s_sub_u32 s60, s38, 192
    s_lshl_b32 s60, s60, 5
    v_add_u32 v47, s60, v47
    v_min_u32 v149, 1055, v46
    v_lshl_add_u32 v149, v149, 10, v47
    v_add_u32 v149, 327680, v149
    v_lshl_add_u32 v148, v46, 10, v47
    global_load_dwordx4 v[100:103], v148, s[26:27]
    v_add_u32 v148, 32768, v148
    global_load_dwordx4 v[104:107], v148, s[26:27]
    v_add_u32 v148, 32768, v148
    global_load_dwordx4 v[108:111], v148, s[26:27]
    v_add_u32 v148, 32768, v148
    global_load_dwordx4 v[112:115], v148, s[26:27]
    v_add_u32 v148, 32768, v148
    global_load_dwordx4 v[116:119], v148, s[26:27]
    v_add_u32 v148, 32768, v148
    global_load_dwordx4 v[120:123], v148, s[26:27]
    v_add_u32 v148, 32768, v148
    s_branch L_w_done
L_w_notdown:
    s_cmp_eq_u32 s68, 1
    s_cbranch_scc0 L_w_done
    s_cmp_eq_u32 s58, 0
    s_cbranch_scc0 L_w_done
    v_lshrrev_b32 v46, 1, v1
    v_mul_u32_u24 v46, 2752, v46
    s_lshl_b32 s60, s38, 4
    v_add_u32 v46, s60, v46
    v_and_b32 v47, 1, v1
    v_cmp_eq_u32 vcc, 1, v47
    s_sub_u32 s60, s24, s22
    s_subb_u32 s61, s25, s23
    v_mov_b32 v49, 0
    v_mov_b32 v50, s60
    v_mov_b32 v51, s61
    v_cndmask_b32 v50, v49, v50, vcc
    v_cndmask_b32 v51, v49, v51, vcc
    v_add_co_u32 v48, vcc, v46, v50
    s_nop 1
    v_addc_co_u32 v49, vcc, v49, v51, vcc
    v_mov_b32 v50, s23
    s_nop 0
    v_add_co_u32 v48, vcc, s22, v48
    s_nop 1
    v_addc_co_u32 v49, vcc, v49, v50, vcc
    global_load_dwordx4 v[100:103], v[48:49], off
    s_nop 0
    v_add_co_u32 v48, vcc, 88064, v48
    s_nop 1
    v_addc_co_u32 v49, vcc, 0, v49, vcc
    global_load_dwordx4 v[104:107], v[48:49], off
    s_nop 0
    v_add_co_u32 v48, vcc, 88064, v48
    s_nop 1
    v_addc_co_u32 v49, vcc, 0, v49, vcc
    global_load_dwordx4 v[108:111], v[48:49], off
    s_nop 0
    v_add_co_u32 v48, vcc, 88064, v48
    s_nop 1
    v_addc_co_u32 v49, vcc, 0, v49, vcc
    global_load_dwordx4 v[112:115], v[48:49], off
    s_nop 0
    v_add_co_u32 v48, vcc, 88064, v48
    s_nop 1
    v_addc_co_u32 v49, vcc, 0, v49, vcc
    global_load_dwordx4 v[116:119], v[48:49], off
    s_nop 0
    v_add_co_u32 v48, vcc, 88064, v48
    s_nop 1
    v_addc_co_u32 v49, vcc, 0, v49, vcc
    global_load_dwordx4 v[120:123], v[48:49], off
    s_nop 0
    v_add_co_u32 v48, vcc, 88064, v48
    s_nop 1
    v_addc_co_u32 v49, vcc, 0, v49, vcc
    global_load_dwordx4 v[124:127], v[48:49], off
    s_nop 0
    v_add_co_u32 v48, vcc, 88064, v48
    s_nop 1
    v_addc_co_u32 v49, vcc, 0, v49, vcc
    global_load_dwordx4 v[128:131], v[48:49], off
    s_nop 0
    v_add_co_u32 v48, vcc, 88064, v48
    s_nop 1
    v_addc_co_u32 v49, vcc, 0, v49, vcc
    global_load_dwordx4 v[132:135], v[48:49], off
    s_nop 0
    v_add_co_u32 v48, vcc, 88064, v48
    s_nop 1
    v_addc_co_u32 v49, vcc, 0, v49, vcc
    global_load_dwordx4 v[136:139], v[48:49], off
    s_nop 0
    v_add_co_u32 v48, vcc, 88064, v48
    s_nop 1
    v_addc_co_u32 v49, vcc, 0, v49, vcc
    global_load_dwordx4 v[140:143], v[48:49], off
    s_nop 0
    v_add_co_u32 v48, vcc, 88064, v48
    s_nop 1
    v_addc_co_u32 v49, vcc, 0, v49, vcc
    global_load_dwordx4 v[144:147], v[48:49], off
    s_nop 0
    v_add_co_u32 v48, vcc, 88064, v48
    s_nop 1
    v_addc_co_u32 v49, vcc, 0, v49, vcc
    global_load_dwordx4 v[148:151], v[48:49], off
    s_nop 0
    v_add_co_u32 v48, vcc, 88064, v48
    s_nop 1
    v_addc_co_u32 v49, vcc, 0, v49, vcc
    global_load_dwordx4 v[152:155], v[48:49], off
    s_nop 0
    v_add_co_u32 v48, vcc, 88064, v48
    s_nop 1
    v_addc_co_u32 v49, vcc, 0, v49, vcc
    global_load_dwordx4 v[156:159], v[48:49], off
    s_nop 0
    v_add_co_u32 v48, vcc, 88064, v48
    s_nop 1
    v_addc_co_u32 v49, vcc, 0, v49, vcc
    global_load_dwordx4 v[160:163], v[48:49], off
L_w_done:
    s_waitcnt lgkmcnt(0)
    s_barrier
L_tst:
    v_lshlrev_b32 v64, 16, v4
    v_and_b32 v65, s44, v4
    v_lshlrev_b32 v66, 16, v5
    v_and_b32 v67, s44, v5
    v_lshlrev_b32 v68, 16, v6
    v_and_b32 v69, s44, v6
    v_lshlrev_b32 v70, 16, v7
    v_and_b32 v71, s44, v7
    v_readfirstlane_b32 s66, v64
    v_lshrrev_b32 v44, 1, v0
    v_lshlrev_b32 v44, 13, v44
    v_and_b32 v45, 1, v0
    v_lshl_add_u32 v44, v45, 4, v44
    s_lshl_b32 s58, s38, 5
    s_add_u32 s58, s58, 2097152
    v_add_u32 v44, s58, v44
    v_pk_add_f32 v[64:65], v[64:65], s[66:67] op_sel_hi:[1,0] neg_lo:[0,1] neg_hi:[0,1]
    v_pk_add_f32 v[66:67], v[66:67], s[66:67] op_sel_hi:[1,0] neg_lo:[0,1] neg_hi:[0,1]
    v_pk_add_f32 v[68:69], v[68:69], s[66:67] op_sel_hi:[1,0] neg_lo:[0,1] neg_hi:[0,1]
    v_pk_add_f32 v[70:71], v[70:71], s[66:67] op_sel_hi:[1,0] neg_lo:[0,1] neg_hi:[0,1]
    s_cmp_lt_u32 s39, 4
    s_cbranch_scc1 L_w2_done
    v_subrev_u32 v32, 256, v0
    v_lshlrev_b32 v44, 4, v32
    v_add_u32 v44, 1323008, v44
    v_lshlrev_b32 v45, 2, v32
    global_load_dword v54, v45, s[20:21]
    s_mov_b32 s47, 0
L_p2_14:
    s_add_u32 s47, s47, 1
    s_cmp_gt_u32 s47, 40000
    s_cbranch_scc1 L_p2x_15
    v_mov_b32 v46, v44
    global_load_dwordx4 v[200:203], v46, s[36:37] sc1
    v_add_u32 v48, 4096, v46
    global_load_dwordx4 v[216:219], v48, s[36:37] sc1
    v_add_u32 v48, 8192, v46
    global_load_dwordx4 v[232:235], v48, s[36:37] sc1
    v_add_u32 v46, 24576, v46
    global_load_dwordx4 v[204:207], v46, s[36:37] sc1
    v_add_u32 v48, 4096, v46
    global_load_dwordx4 v[220:223], v48, s[36:37] sc1
    v_add_u32 v48, 8192, v46
    global_load_dwordx4 v[236:239], v48, s[36:37] sc1
    v_add_u32 v46, 24576, v46
    global_load_dwordx4 v[208:211], v46, s[36:37] sc1
    v_add_u32 v48, 4096, v46
    global_load_dwordx4 v[224:227], v48, s[36:37] sc1
    v_add_u32 v48, 8192, v46
    global_load_dwordx4 v[240:243], v48, s[36:37] sc1
    v_add_u32 v46, 24576, v46
    global_load_dwordx4 v[212:215], v46, s[36:37] sc1
    v_add_u32 v48, 4096, v46
    global_load_dwordx4 v[228:231], v48, s[36:37] sc1
    v_add_u32 v48, 8192, v46
    global_load_dwordx4 v[244:247], v48, s[36:37] sc1
    s_waitcnt vmcnt(0)
    v_mov_b32 v48, 0
    v_xor_b32 v49, s40, v202
    v_or_b32 v48, v48, v49
    v_xor_b32 v49, s40, v206
    v_or_b32 v48, v48, v49
    v_xor_b32 v49, s40, v210
    v_or_b32 v48, v48, v49
    v_xor_b32 v49, s40, v214
    v_or_b32 v48, v48, v49
    v_xor_b32 v49, s40, v218
    v_or_b32 v48, v48, v49
    v_xor_b32 v49, s40, v222
    v_or_b32 v48, v48, v49
    v_xor_b32 v49, s40, v226
    v_or_b32 v48, v48, v49
    v_xor_b32 v49, s40, v230
    v_or_b32 v48, v48, v49
    v_xor_b32 v49, s40, v234
    v_or_b32 v48, v48, v49
    v_xor_b32 v49, s40, v238
    v_or_b32 v48, v48, v49
    v_xor_b32 v49, s40, v242
    v_or_b32 v48, v48, v49
    v_xor_b32 v49, s40, v246
    v_or_b32 v48, v48, v49
    v_cmp_ne_u32 vcc, 0, v48
    s_cbranch_vccnz L_p2_14
L_p2x_15:
    v_pk_add_f32 v[200:201], v[200:201], v[204:205]
    v_pk_add_f32 v[208:209], v[208:209], v[212:213]
    v_pk_add_f32 v[200:201], v[200:201], v[208:209]
    v_cvt_pk_bf16_f32 v56, v200, v201
    v_pk_add_f32 v[216:217], v[216:217], v[220:221]
    v_pk_add_f32 v[224:225], v[224:225], v[228:229]
    v_pk_add_f32 v[216:217], v[216:217], v[224:225]
    v_cvt_pk_bf16_f32 v58, v216, v217
    v_pk_add_f32 v[232:233], v[232:233], v[236:237]
    v_pk_add_f32 v[240:241], v[240:241], v[244:245]
    v_pk_add_f32 v[232:233], v[232:233], v[240:241]
    v_cvt_pk_bf16_f32 v60, v232, v233
    v_lshlrev_b32 v44, 3, v32
    v_add_u32 v44, 42240, v44
    v_lshlrev_b32 v46, 16, v58
    v_and_b32 v47, s44, v58
    v_add_f32 v46, 1.0, v46
    v_add_f32 v47, 1.0, v47
    v_cvt_pk_bf16_f32 v47, v46, v47
    v_lshlrev_b32 v46, 16, v47
    v_and_b32 v47, s44, v47
    ds_write_b64 v44, v[46:47]
    v_lshlrev_b32 v48, 16, v56
    v_and_b32 v49, s44, v56
    ds_write_b64 v44, v[48:49] offset:2048
    v_lshlrev_b32 v50, 16, v60
    v_and_b32 v51, s44, v60
    ds_write_b64 v44, v[50:51] offset:4096
    v_lshlrev_b32 v52, 16, v54
    v_and_b32 v53, s44, v54
    ds_write_b64 v44, v[52:53] offset:6144
    s_cmp_eq_u32 s68, 1
    s_cbranch_scc0 L_no_gu_stage
    s_cmp_eq_u32 s39, 4
    s_cbranch_scc0 L_no_gu_stage
    v_lshlrev_b32 v46, 4, v1
    v_add_u32 v46, 88896, v46
    ds_write_b128 v46, v[100:103] offset:0
    ds_write_b128 v46, v[104:107] offset:1024
    ds_write_b128 v46, v[108:111] offset:2048
    ds_write_b128 v46, v[112:115] offset:3072
    ds_write_b128 v46, v[116:119] offset:4096
    ds_write_b128 v46, v[120:123] offset:5120
    ds_write_b128 v46, v[124:127] offset:6144
    ds_write_b128 v46, v[128:131] offset:7168
    ds_write_b128 v46, v[132:135] offset:8192
    ds_write_b128 v46, v[136:139] offset:9216
    ds_write_b128 v46, v[140:143] offset:10240
    ds_write_b128 v46, v[144:147] offset:11264
    ds_write_b128 v46, v[148:151] offset:12288
    ds_write_b128 v46, v[152:155] offset:13312
    ds_write_b128 v46, v[156:159] offset:14336
    ds_write_b128 v46, v[160:163] offset:15360
    v_and_b32 v47, 15, v1
    v_lshrrev_b32 v47, 2, v47
    v_lshrrev_b32 v48, 4, v1
    v_lshl_add_u32 v47, v48, 3, v47
    v_lshlrev_b32 v47, 5, v47
    v_and_b32 v48, 3, v1
    v_lshl_add_u32 v47, v48, 3, v47
    v_add_u32 v47, 88896, v47
    s_waitcnt lgkmcnt(0)
    ds_read_b64_tr_b16 v[100:101], v47 offset:0
    ds_read_b64_tr_b16 v[102:103], v47 offset:128
    ds_read_b64_tr_b16 v[104:105], v47 offset:1024
    ds_read_b64_tr_b16 v[106:107], v47 offset:1152
    ds_read_b64_tr_b16 v[108:109], v47 offset:2048
    ds_read_b64_tr_b16 v[110:111], v47 offset:2176
    ds_read_b64_tr_b16 v[112:113], v47 offset:3072
    ds_read_b64_tr_b16 v[114:115], v47 offset:3200
    ds_read_b64_tr_b16 v[116:117], v47 offset:4096
    ds_read_b64_tr_b16 v[118:119], v47 offset:4224
    ds_read_b64_tr_b16 v[120:121], v47 offset:5120
    ds_read_b64_tr_b16 v[122:123], v47 offset:5248
    ds_read_b64_tr_b16 v[124:125], v47 offset:6144
    ds_read_b64_tr_b16 v[126:127], v47 offset:6272
    ds_read_b64_tr_b16 v[128:129], v47 offset:7168
    ds_read_b64_tr_b16 v[130:131], v47 offset:7296
    ds_read_b64_tr_b16 v[132:133], v47 offset:8192
    ds_read_b64_tr_b16 v[134:135], v47 offset:8320
    ds_read_b64_tr_b16 v[136:137], v47 offset:9216
    ds_read_b64_tr_b16 v[138:139], v47 offset:9344
    ds_read_b64_tr_b16 v[140:141], v47 offset:10240
    ds_read_b64_tr_b16 v[142:143], v47 offset:10368
    ds_read_b64_tr_b16 v[144:145], v47 offset:11264
    ds_read_b64_tr_b16 v[146:147], v47 offset:11392
    ds_read_b64_tr_b16 v[148:149], v47 offset:12288
    ds_read_b64_tr_b16 v[150:151], v47 offset:12416
    ds_read_b64_tr_b16 v[152:153], v47 offset:13312
    ds_read_b64_tr_b16 v[154:155], v47 offset:13440
    ds_read_b64_tr_b16 v[156:157], v47 offset:14336
    ds_read_b64_tr_b16 v[158:159], v47 offset:14464
    ds_read_b64_tr_b16 v[160:161], v47 offset:15360
    ds_read_b64_tr_b16 v[162:163], v47 offset:15488
L_no_gu_stage:
    s_cmp_eq_u32 s68, 2
    s_cbranch_scc0 L_w2_done
    global_load_dwordx4 v[124:127], v148, s[26:27]
    v_add_u32 v148, 32768, v148
    global_load_dwordx4 v[128:131], v148, s[26:27]
    v_add_u32 v148, 32768, v148
    global_load_dwordx4 v[132:135], v148, s[26:27]
    v_add_u32 v148, 32768, v148
    global_load_dwordx4 v[136:139], v148, s[26:27]
    v_add_u32 v148, 32768, v148
    global_load_dwordx4 v[140:143], v149, s[26:27]
L_w2_done:
    s_cmp_lt_u32 s39, 4
    s_cbranch_scc0 L_s2_bar
    v_add_u32 v45, 1048576, v44
    s_waitcnt vmcnt(0)
    s_mov_b32 s47, 0
L_s2_16:
    s_add_u32 s47, s47, 1
    s_cmp_gt_u32 s47, 40000
    s_cbranch_scc1 L_s2x_17
    global_load_dwordx4 v[48:51], v44, s[36:37] sc1
    global_load_dwordx4 v[52:55], v45, s[36:37] sc1
    s_waitcnt vmcnt(0)
    v_max3_u32 v46, v48, v49, v50
    v_max3_u32 v47, v51, v52, v53
    v_max3_u32 v46, v46, v54, v55
    v_max_u32 v46, v46, v47
    v_cmp_eq_u32 vcc, -1, v46
    s_nop 0
    s_and_b64 exec, exec, vcc
    s_cbranch_execnz L_s2_16
L_s2x_17:
    s_mov_b64 exec, -1
    v_lshlrev_b32 v44, 1, v0
    v_add_u32 v44, 133952, v44
    ds_write_b16 v44, v48 offset:0
    ds_write_b16_d16_hi v44, v48 offset:1024
    ds_write_b16 v44, v49 offset:2048
    ds_write_b16_d16_hi v44, v49 offset:3072
    ds_write_b16 v44, v50 offset:4096
    ds_write_b16_d16_hi v44, v50 offset:5120
    ds_write_b16 v44, v51 offset:6144
    ds_write_b16_d16_hi v44, v51 offset:7168
    ds_write_b16 v44, v52 offset:512
    ds_write_b16_d16_hi v44, v52 offset:1536
    ds_write_b16 v44, v53 offset:2560
    ds_write_b16_d16_hi v44, v53 offset:3584
    ds_write_b16 v44, v54 offset:4608
    ds_write_b16_d16_hi v44, v54 offset:5632
    ds_write_b16 v44, v55 offset:6656
    ds_write_b16_d16_hi v44, v55 offset:7680
L_s2_bar:
    s_lshl_b32 s58, s39, 10
    s_add_u32 s58, s58, 133952
    v_lshlrev_b32 v44, 4, v1
    v_add_u32 v44, s58, v44
    s_waitcnt lgkmcnt(0)
    s_barrier
    ds_read_b128 v[48:51], v44
    v_lshlrev_b32 v46, 5, v1
    v_add_u32 v46, 42240, v46
    ds_read_b128 v[168:171], v46 offset:0
    ds_read_b128 v[172:175], v46 offset:16
    ds_read_b128 v[176:179], v46 offset:2048
    ds_read_b128 v[180:183], v46 offset:2064
    ds_read_b128 v[192:195], v46 offset:6144
    ds_read_b128 v[196:199], v46 offset:6160
    ds_read_b128 v[184:187], v46 offset:4096
    ds_read_b128 v[188:191], v46 offset:4112
    s_cmp_eq_u32 s38, 0
    s_cbranch_scc0 L_noepoch2
    s_cmp_eq_u32 s39, 5
    s_cbranch_scc0 L_noepoch2
    s_add_u32 s58, s41, 1
    v_mov_b32 v46, s58
    v_mov_b32 v47, 0
    s_mov_b64 exec, 1
    global_store_dword v47, v46, s[36:37] sc1
    s_mov_b64 exec, -1
L_noepoch2:
    s_waitcnt lgkmcnt(8)
    v_lshlrev_b32 v72, 16, v48
    v_and_b32 v73, s44, v48
    v_lshlrev_b32 v74, 16, v49
    v_and_b32 v75, s44, v49
    v_lshlrev_b32 v76, 16, v50
    v_and_b32 v77, s44, v50
    v_lshlrev_b32 v78, 16, v51
    v_and_b32 v79, s44, v51
    v_pk_add_f32 v[64:65], v[64:65], v[72:73]
    v_pk_add_f32 v[66:67], v[66:67], v[74:75]
    v_pk_add_f32 v[68:69], v[68:69], v[76:77]
    v_pk_add_f32 v[70:71], v[70:71], v[78:79]
    v_pk_add_f32 v[52:53], v[64:65], v[66:67]
    v_pk_mul_f32 v[54:55], v[64:65], v[64:65]
    v_pk_add_f32 v[56:57], v[68:69], v[70:71]
    v_pk_fma_f32 v[54:55], v[66:67], v[66:67], v[54:55]
    v_pk_add_f32 v[52:53], v[52:53], v[56:57]
    v_pk_fma_f32 v[54:55], v[68:69], v[68:69], v[54:55]
    v_add_f32 v52, v52, v53
    v_pk_fma_f32 v[54:55], v[70:71], v[70:71], v[54:55]
    v_add_f32 v54, v54, v55
    v_add_f32_dpp v52, v52, v52 row_shr:1 row_mask:0xf bank_mask:0xf
    s_nop 0
    v_add_f32_dpp v54, v54, v54 row_shr:1 row_mask:0xf bank_mask:0xf
    v_add_f32_dpp v52, v52, v52 row_shr:2 row_mask:0xf bank_mask:0xf
    s_nop 0
    v_add_f32_dpp v54, v54, v54 row_shr:2 row_mask:0xf bank_mask:0xf
    v_add_f32_dpp v52, v52, v52 row_shr:4 row_mask:0xf bank_mask:0xf
    s_nop 0
    v_add_f32_dpp v54, v54, v54 row_shr:4 row_mask:0xf bank_mask:0xf
    v_add_f32_dpp v52, v52, v52 row_shr:8 row_mask:0xf bank_mask:0xf
    s_nop 0
    v_add_f32_dpp v54, v54, v54 row_shr:8 row_mask:0xf bank_mask:0xf
    v_add_f32_dpp v52, v52, v52 row_bcast:15 row_mask:0xa bank_mask:0xf
    s_nop 0
    v_add_f32_dpp v54, v54, v54 row_bcast:15 row_mask:0xa bank_mask:0xf
    v_add_f32_dpp v52, v52, v52 row_bcast:31 row_mask:0xc bank_mask:0xf
    s_nop 0
    v_add_f32_dpp v54, v54, v54 row_bcast:31 row_mask:0xc bank_mask:0xf
    v_mul_f32 v52, 0x3b000000, v52
    v_mul_f32 v54, 0x3b000000, v54
    v_fma_f32 v54, -v52, v52, v54
    v_add_f32 v52, s66, v52
    v_max_f32 v54, 0, v54
    v_cvt_pk_bf16_f32 v54, v54, v54
    v_and_b32 v54, s44, v54
    v_add_f32 v54, 0x3727c5ac, v54
    v_cvt_pk_bf16_f32 v54, v54, v54
    v_and_b32 v54, s44, v54
    v_sqrt_f32 v54, v54
    s_nop 0
    v_cvt_pk_bf16_f32 v52, v52, v54
    v_mov_b32 v56, s66
    v_readlane_b32 s58, v52, 63
    s_nop 0
    s_and_b32 s59, s58, s44
    s_lshl_b32 s58, s58, 16
    v_rcp_f32 v60, s59
    v_sub_f32 v62, s58, v56
    s_waitcnt lgkmcnt(0)
    v_pk_add_f32 v[80:81], v[64:65], v[62:63] op_sel_hi:[1,0] neg_lo:[0,1] neg_hi:[0,1]
    v_pk_add_f32 v[82:83], v[66:67], v[62:63] op_sel_hi:[1,0] neg_lo:[0,1] neg_hi:[0,1]
    v_pk_add_f32 v[84:85], v[68:69], v[62:63] op_sel_hi:[1,0] neg_lo:[0,1] neg_hi:[0,1]
    v_pk_add_f32 v[86:87], v[70:71], v[62:63] op_sel_hi:[1,0] neg_lo:[0,1] neg_hi:[0,1]
    v_pk_mul_f32 v[80:81], v[80:81], v[60:61] op_sel_hi:[1,0]
    v_pk_mul_f32 v[82:83], v[82:83], v[60:61] op_sel_hi:[1,0]
    v_pk_mul_f32 v[84:85], v[84:85], v[60:61] op_sel_hi:[1,0]
    v_pk_mul_f32 v[86:87], v[86:87], v[60:61] op_sel_hi:[1,0]
    v_pk_fma_f32 v[80:81], v[80:81], v[168:169], v[176:177]
    v_pk_fma_f32 v[82:83], v[82:83], v[170:171], v[178:179]
    v_pk_fma_f32 v[84:85], v[84:85], v[172:173], v[180:181]
    v_pk_fma_f32 v[86:87], v[86:87], v[174:175], v[182:183]
    v_pk_mul_f32 v[52:53], v[80:81], v[192:193]
    v_pk_fma_f32 v[52:53], v[82:83], v[194:195], v[52:53]
    v_pk_fma_f32 v[52:53], v[84:85], v[196:197], v[52:53]
    v_pk_fma_f32 v[52:53], v[86:87], v[198:199], v[52:53]
    v_add_f32 v52, v52, v53
    v_pk_add_f32 v[64:65], v[64:65], v[56:57] op_sel_hi:[1,0]
    s_nop 0
    v_add_f32_dpp v52, v52, v52 row_shr:1 row_mask:0xf bank_mask:0xf
    v_pk_add_f32 v[66:67], v[66:67], v[56:57] op_sel_hi:[1,0]
    s_nop 0
    v_add_f32_dpp v52, v52, v52 row_shr:2 row_mask:0xf bank_mask:0xf
    v_pk_add_f32 v[68:69], v[68:69], v[56:57] op_sel_hi:[1,0]
    s_nop 0
    v_add_f32_dpp v52, v52, v52 row_shr:4 row_mask:0xf bank_mask:0xf
    v_pk_add_f32 v[70:71], v[70:71], v[56:57] op_sel_hi:[1,0]
    s_nop 0
    v_add_f32_dpp v52, v52, v52 row_shr:8 row_mask:0xf bank_mask:0xf
    v_pk_fma_f32 v[72:73], v[80:81], v[184:185], v[64:65]
    v_pk_fma_f32 v[74:75], v[82:83], v[186:187], v[66:67]
    v_add_f32_dpp v52, v52, v52 row_bcast:15 row_mask:0xa bank_mask:0xf
    v_pk_fma_f32 v[76:77], v[84:85], v[188:189], v[68:69]
    v_pk_fma_f32 v[78:79], v[86:87], v[190:191], v[70:71]
    v_add_f32_dpp v52, v52, v52 row_bcast:31 row_mask:0xc bank_mask:0xf
    s_lshl_b32 s64, s38, 3
    s_add_u32 s64, s64, s39
    s_sub_u32 s59, 2047, s64
    s_lshl_b32 s61, s59, 1
    s_lshl_b32 s58, s39, 2
    s_add_u32 s58, s58, 88128
    v_mov_b32 v53, s58
    v_cvt_pk_bf16_f32 v52, v52, v52
    v_ashrrev_i32 v54, 31, v52
    v_or_b32 v54, 0x80000000, v54
    v_xor_b32 v52, v52, v54
    v_and_b32 v52, s44, v52
    v_or_b32 v52, s61, v52
    s_mov_b32 exec_lo, 0
    s_mov_b32 exec_hi, 0x80000000
    ds_write_b32 v53, v52
    s_mov_b64 exec, -1
    v_mov_b32 v53, 88128
    v_readlane_b32 s63, v52, 63
    v_cvt_pk_bf16_f32 v96, v72, v73
    v_cvt_pk_bf16_f32 v92, v64, v65
    v_cvt_pk_bf16_f32 v88, v80, v81
    v_cvt_pk_bf16_f32 v97, v74, v75
    v_cvt_pk_bf16_f32 v93, v66, v67
    v_cvt_pk_bf16_f32 v89, v82, v83
    v_cvt_pk_bf16_f32 v98, v76, v77
    v_cvt_pk_bf16_f32 v94, v68, v69
    v_cvt_pk_bf16_f32 v90, v84, v85
    v_cvt_pk_bf16_f32 v99, v78, v79
    v_cvt_pk_bf16_f32 v95, v70, v71
    v_cvt_pk_bf16_f32 v91, v86, v87
    s_lshl_b32 s60, s64, 10
    v_lshlrev_b32 v44, 4, v1
    v_add_u32 v45, s60, v44
    s_waitcnt lgkmcnt(0)
    s_barrier
    ds_read_b128 v[56:59], v53
    ds_read_b128 v[60:63], v53 offset:16
    s_waitcnt lgkmcnt(0)
    v_max_u32 v64, v56, v57
    v_min_u32 v57, v56, v57
    v_max_u32 v65, v58, v59
    v_min_u32 v59, v58, v59
    v_max_u32 v66, v60, v61
    v_min_u32 v61, v60, v61
    v_max_u32 v67, v62, v63
    v_min_u32 v63, v62, v63
    v_min_u32 v56, v64, v65
    v_max_u32 v64, v64, v65
    v_max3_u32 v57, v56, v57, v59
    v_min_u32 v56, v66, v67
    v_max_u32 v66, v66, v67
    v_max3_u32 v61, v56, v61, v63
    v_min_u32 v56, v64, v66
    v_max_u32 v52, v64, v66
    v_max3_u32 v53, v56, v57, v61
    s_mov_b32 s65, 0
    v_readfirstlane_b32 s58, v52
    v_readfirstlane_b32 s59, v53
    s_nop 0
    s_or_b32 s59, s59, 1
    s_cmp_eq_u32 s63, s58
    s_cbranch_scc1 L_cand0
    s_or_b32 s60, s63, 1
    s_cmp_eq_u32 s60, s59
    s_cbranch_scc1 L_cand1
    global_store_dwordx4 v45, v[96:99], s[32:33] sc1
    s_branch L_cand_done
L_cand1:
    s_mov_b32 s60, 2048
    s_branch L_cand_store
L_cand0:
    v_mov_b32 v52, s58
    v_mov_b32 v53, s59
    s_lshl_b32 s60, s38, 6
    s_add_u32 s60, s60, 1572864
    v_mov_b32 v54, s60
    s_mov_b64 exec, 1
    global_store_dwordx2 v54, v[52:53], s[36:37] sc1
    s_mov_b64 exec, -1
    s_mov_b32 s60, 0
L_cand_store:
    s_mov_b32 s65, 1
    s_lshl_b32 s61, s38, 12
    s_add_u32 s60, s60, s61
    s_add_u32 s60, s60, 65536
    v_add_u32 v46, s60, v44
    v_min_u32 v88, -2, v88
    v_min_u32 v92, -2, v92
    v_min_u32 v89, -2, v89
    v_min_u32 v93, -2, v93
    v_min_u32 v90, -2, v90
    v_min_u32 v94, -2, v94
    v_min_u32 v91, -2, v91
    v_min_u32 v95, -2, v95
    global_store_dwordx4 v46, v[88:91], s[36:37] sc1
    global_store_dwordx4 v46, v[92:95], s[36:37] offset:1024 sc1
L_cand_done:
    s_mov_b32 s68, 0
    s_cmp_lt_u32 s39, 4
    s_cbranch_scc1 L_role_done
    s_cmp_lt_u32 s38, 172
    s_cbranch_scc0 L_role_nogu
    s_cmp_eq_u32 s39, 4
    s_cselect_b32 s68, 1, 0
    s_branch L_role_done
L_role_nogu:
    s_cmp_lt_u32 s38, 192
    s_cbranch_scc1 L_role_done
    s_cmp_lt_u32 s38, 224
    s_cselect_b32 s68, 2, 0
L_role_done:
    s_sub_u32 s72, s39, 4
    s_cmp_eq_u32 s68, 2
    s_cbranch_scc0 L_st_done
    s_waitcnt vmcnt(0)
    s_mul_i32 s59, s72, 11264
    s_add_u32 s59, s59, 88896
    v_lshlrev_b32 v46, 4, v1
    v_add_u32 v46, s59, v46
    s_cmp_eq_u32 s72, 3
    s_cbranch_scc0 L_st_nz
    v_mov_b32 v140, 0
    v_mov_b32 v141, 0
    v_mov_b32 v142, 0
    v_mov_b32 v143, 0
L_st_nz:
    ds_write_b128 v46, v[100:103] offset:0
    ds_write_b128 v46, v[104:107] offset:1024
    ds_write_b128 v46, v[108:111] offset:2048
    ds_write_b128 v46, v[112:115] offset:3072
    ds_write_b128 v46, v[116:119] offset:4096
    ds_write_b128 v46, v[120:123] offset:5120
    ds_write_b128 v46, v[124:127] offset:6144
    ds_write_b128 v46, v[128:131] offset:7168
    ds_write_b128 v46, v[132:135] offset:8192
    ds_write_b128 v46, v[136:139] offset:9216
    ds_write_b128 v46, v[140:143] offset:10240
    v_and_b32 v47, 15, v1
    v_lshrrev_b32 v47, 2, v47
    v_lshrrev_b32 v48, 4, v1
    v_lshl_add_u32 v47, v48, 3, v47
    v_lshlrev_b32 v47, 5, v47
    v_and_b32 v48, 3, v1
    v_lshl_add_u32 v47, v48, 3, v47
    v_add_u32 v47, s59, v47
    s_waitcnt lgkmcnt(0)
    ds_read_b64_tr_b16 v[100:101], v47 offset:0
    ds_read_b64_tr_b16 v[102:103], v47 offset:128
    ds_read_b64_tr_b16 v[104:105], v47 offset:1024
    ds_read_b64_tr_b16 v[106:107], v47 offset:1152
    ds_read_b64_tr_b16 v[108:109], v47 offset:2048
    ds_read_b64_tr_b16 v[110:111], v47 offset:2176
    ds_read_b64_tr_b16 v[112:113], v47 offset:3072
    ds_read_b64_tr_b16 v[114:115], v47 offset:3200
    ds_read_b64_tr_b16 v[116:117], v47 offset:4096
    ds_read_b64_tr_b16 v[118:119], v47 offset:4224
    ds_read_b64_tr_b16 v[120:121], v47 offset:5120
    ds_read_b64_tr_b16 v[122:123], v47 offset:5248
    ds_read_b64_tr_b16 v[124:125], v47 offset:6144
    ds_read_b64_tr_b16 v[126:127], v47 offset:6272
    ds_read_b64_tr_b16 v[128:129], v47 offset:7168
    ds_read_b64_tr_b16 v[130:131], v47 offset:7296
    ds_read_b64_tr_b16 v[132:133], v47 offset:8192
    ds_read_b64_tr_b16 v[134:135], v47 offset:8320
    ds_read_b64_tr_b16 v[136:137], v47 offset:9216
    ds_read_b64_tr_b16 v[138:139], v47 offset:9344
    ds_read_b64_tr_b16 v[140:141], v47 offset:10240
    ds_read_b64_tr_b16 v[142:143], v47 offset:10368
L_st_done:
    s_cmp_eq_u32 s39, 4
    s_cbranch_scc1 L_s3
    s_cmp_eq_u32 s65, 1
    s_cbranch_scc1 L_s3_wait
    s_cmp_lg_u32 s68, 0
    s_cbranch_scc1 L_s3_wait
    s_branch L_end
L_s3:
    v_lshlrev_b32 v44, 6, v1
    v_add_u32 v44, 1572864, v44
    v_add_u32 v46, 8192, v44
    v_add_u32 v47, 4096, v44
    v_add_u32 v48, 12288, v44
    s_waitcnt vmcnt(0)
    s_mov_b32 s47, 0
L_s3_18:
    s_add_u32 s47, s47, 1
    s_cmp_gt_u32 s47, 40000
    s_cbranch_scc1 L_s3x_19
    global_load_dwordx2 v[56:57], v44, s[36:37] sc1
    global_load_dwordx2 v[58:59], v47, s[36:37] sc1
    global_load_dwordx2 v[60:61], v46, s[36:37] sc1
    global_load_dwordx2 v[62:63], v48, s[36:37] sc1
    s_waitcnt vmcnt(0)
    v_max3_u32 v52, v56, v57, v58
    v_max3_u32 v53, v59, v60, v61
    v_max3_u32 v52, v52, v62, v63
    v_max_u32 v52, v52, v53
    v_cmp_eq_u32 vcc, -1, v52
    s_nop 0
    s_and_b64 exec, exec, vcc
    s_cbranch_execnz L_s3_18
L_s3x_19:
    s_mov_b64 exec, -1
    v_max_u32 v64, v56, v57
    v_min_u32 v57, v56, v57
    v_max_u32 v65, v58, v59
    v_min_u32 v59, v58, v59
    v_max_u32 v66, v60, v61
    v_min_u32 v61, v60, v61
    v_max_u32 v67, v62, v63
    v_min_u32 v63, v62, v63
    v_min_u32 v56, v64, v65
    v_max_u32 v64, v64, v65
    v_max3_u32 v57, v56, v57, v59
    v_min_u32 v56, v66, v67
    v_max_u32 v66, v66, v67
    v_max3_u32 v61, v56, v61, v63
    v_min_u32 v56, v64, v66
    v_max_u32 v52, v64, v66
    v_max3_u32 v53, v56, v57, v61
    s_nop 0
    v_min_u32_dpp v54, v52, v52 row_shr:1 row_mask:0xf bank_mask:0xf bound_ctrl:0
    v_max_u32_dpp v55, v53, v53 row_shr:1 row_mask:0xf bank_mask:0xf bound_ctrl:0
    v_max_u32_dpp v52, v52, v52 row_shr:1 row_mask:0xf bank_mask:0xf bound_ctrl:0
    v_max_u32 v53, v54, v55
    s_nop 0
    v_min_u32_dpp v54, v52, v52 row_shr:2 row_mask:0xf bank_mask:0xf bound_ctrl:0
    v_max_u32_dpp v55, v53, v53 row_shr:2 row_mask:0xf bank_mask:0xf bound_ctrl:0
    v_max_u32_dpp v52, v52, v52 row_shr:2 row_mask:0xf bank_mask:0xf bound_ctrl:0
    v_max_u32 v53, v54, v55
    s_nop 0
    v_min_u32_dpp v54, v52, v52 row_shr:4 row_mask:0xf bank_mask:0xf bound_ctrl:0
    v_max_u32_dpp v55, v53, v53 row_shr:4 row_mask:0xf bank_mask:0xf bound_ctrl:0
    v_max_u32_dpp v52, v52, v52 row_shr:4 row_mask:0xf bank_mask:0xf bound_ctrl:0
    v_max_u32 v53, v54, v55
    s_nop 0
    v_min_u32_dpp v54, v52, v52 row_shr:8 row_mask:0xf bank_mask:0xf bound_ctrl:0
    v_max_u32_dpp v55, v53, v53 row_shr:8 row_mask:0xf bank_mask:0xf bound_ctrl:0
    v_max_u32_dpp v52, v52, v52 row_shr:8 row_mask:0xf bank_mask:0xf bound_ctrl:0
    v_max_u32 v53, v54, v55
    s_nop 0
    v_min_u32_dpp v54, v52, v52 row_bcast:15 row_mask:0xa bank_mask:0xf bound_ctrl:0
    v_max_u32_dpp v55, v53, v53 row_bcast:15 row_mask:0xa bank_mask:0xf bound_ctrl:0
    v_max_u32_dpp v52, v52, v52 row_bcast:15 row_mask:0xa bank_mask:0xf bound_ctrl:0
    v_max_u32 v53, v54, v55
    s_nop 0
    v_min_u32_dpp v54, v52, v52 row_bcast:31 row_mask:0xc bank_mask:0xf bound_ctrl:0
    v_max_u32_dpp v55, v53, v53 row_bcast:31 row_mask:0xc bank_mask:0xf bound_ctrl:0
    v_max_u32_dpp v52, v52, v52 row_bcast:31 row_mask:0xc bank_mask:0xf bound_ctrl:0
    v_max_u32 v53, v54, v55
    v_mov_b32 v54, 88160
    s_mov_b32 exec_lo, 0
    s_mov_b32 exec_hi, 0x80000000
    ds_write_b64 v54, v[52:53]
    s_mov_b64 exec, -1
    v_readlane_b32 s70, v52, 63
    v_readlane_b32 s71, v53, 63
    s_waitcnt lgkmcnt(0)
    s_barrier
    s_branch L_s3_have
L_s3_wait:
    v_mov_b32 v54, 88160
    s_waitcnt lgkmcnt(0)
    s_barrier
    ds_read_b64 v[52:53], v54
    s_waitcnt lgkmcnt(0)
    v_readfirstlane_b32 s70, v52
    v_readfirstlane_b32 s71, v53
L_s3_have:
    s_cmp_eq_u32 s65, 1
    s_cbranch_scc0 L_nocand_fin
    s_lshr_b32 s58, s63, 1
    s_lshr_b32 s59, s70, 1
    s_cmp_eq_u32 s58, s59
    s_cbranch_scc1 L_nocand_fin
    s_lshr_b32 s59, s71, 1
    s_cmp_eq_u32 s58, s59
    s_cbranch_scc1 L_nocand_fin
L_store_out:
    global_store_dwordx4 v45, v[96:99], s[32:33] sc1
L_nocand_fin:
    s_cmp_eq_u32 s68, 0
    s_cbranch_scc1 L_end
    s_lshr_b32 s58, s70, 1
    s_and_b32 s58, s58, 0x7ff
    s_sub_u32 s76, 2047, s58
    s_lshr_b32 s58, s76, 3
    s_lshl_b32 s58, s58, 12
    s_and_b32 s59, s70, 1
    s_lshl_b32 s59, s59, 11
    s_add_u32 s58, s58, s59
    s_add_u32 s74, s58, 65536
    s_lshr_b32 s58, s71, 1
    s_and_b32 s58, s58, 0x7ff
    s_sub_u32 s77, 2047, s58
    s_lshr_b32 s58, s77, 3
    s_lshl_b32 s58, s58, 12
    s_and_b32 s59, s71, 1
    s_lshl_b32 s59, s59, 11
    s_add_u32 s58, s58, s59
    s_add_u32 s75, s58, 65536
    v_and_b32 v244, 15, v1
    v_lshrrev_b32 v245, 4, v1
    v_cmp_eq_u32 vcc, 1, v244
    v_mov_b32 v246, s74
    v_mov_b32 v247, s75
    v_cndmask_b32 v246, v246, v247, vcc
    s_cmp_eq_u32 s68, 1
    s_cbranch_scc0 L_down
    v_lshl_add_u32 v246, v245, 4, v246
    v_cmp_gt_u32 vcc, 2, v244
    s_nop 0
    s_and_saveexec_b64 s[48:49], vcc
    s_mov_b32 s47, 0
L_s3r_20:
    s_add_u32 s47, s47, 1
    s_cmp_gt_u32 s47, 40000
    s_cbranch_scc1 L_s3rx_21
    global_load_dwordx4 v[168:171], v246, s[36:37] offset:0 sc1
    global_load_dwordx4 v[172:175], v246, s[36:37] offset:64 sc1
    global_load_dwordx4 v[176:179], v246, s[36:37] offset:128 sc1
    global_load_dwordx4 v[180:183], v246, s[36:37] offset:192 sc1
    global_load_dwordx4 v[184:187], v246, s[36:37] offset:256 sc1
    global_load_dwordx4 v[188:191], v246, s[36:37] offset:320 sc1
    global_load_dwordx4 v[192:195], v246, s[36:37] offset:384 sc1
    global_load_dwordx4 v[196:199], v246, s[36:37] offset:448 sc1
    global_load_dwordx4 v[200:203], v246, s[36:37] offset:512 sc1
    global_load_dwordx4 v[204:207], v246, s[36:37] offset:576 sc1
    global_load_dwordx4 v[208:211], v246, s[36:37] offset:640 sc1
    global_load_dwordx4 v[212:215], v246, s[36:37] offset:704 sc1
    global_load_dwordx4 v[216:219], v246, s[36:37] offset:768 sc1
    global_load_dwordx4 v[220:223], v246, s[36:37] offset:832 sc1
    global_load_dwordx4 v[224:227], v246, s[36:37] offset:896 sc1
    global_load_dwordx4 v[228:231], v246, s[36:37] offset:960 sc1
    s_waitcnt vmcnt(0)
    v_max3_u32 v247, v168, v171, v172
    v_max3_u32 v247, v247, v175, v176
    v_max3_u32 v247, v247, v179, v180
    v_max3_u32 v247, v247, v183, v184
    v_max3_u32 v247, v247, v187, v188
    v_max3_u32 v247, v247, v191, v192
    v_max3_u32 v247, v247, v195, v196
    v_max_u32 v247, v247, v199
    v_max3_u32 v248, v200, v203, v204
    v_max3_u32 v248, v248, v207, v208
    v_max3_u32 v248, v248, v211, v212
    v_max3_u32 v248, v248, v215, v216
    v_max3_u32 v248, v248, v219, v220
    v_max3_u32 v248, v248, v223, v224
    v_max3_u32 v248, v248, v227, v228
    v_max_u32 v248, v248, v231
    v_max_u32 v247, v247, v248
    v_cmp_eq_u32 vcc, -1, v247
    s_cbranch_vccnz L_s3r_20
L_s3rx_21:
    s_mov_b64 exec, s[48:49]
    s_waitcnt lgkmcnt(0)
    v_mfma_f32_16x16x32_bf16 v[88:91], v[168:171], v[100:103], 0
    v_mfma_f32_16x16x32_bf16 v[92:95], v[172:175], v[104:107], 0
    v_mfma_f32_16x16x32_bf16 v[88:91], v[176:179], v[108:111], v[88:91]
    v_mfma_f32_16x16x32_bf16 v[92:95], v[180:183], v[112:115], v[92:95]
    v_mfma_f32_16x16x32_bf16 v[88:91], v[184:187], v[116:119], v[88:91]
    v_mfma_f32_16x16x32_bf16 v[92:95], v[188:191], v[120:123], v[92:95]
    v_mfma_f32_16x16x32_bf16 v[88:91], v[192:195], v[124:127], v[88:91]
    v_mfma_f32_16x16x32_bf16 v[92:95], v[196:199], v[128:131], v[92:95]
    v_mfma_f32_16x16x32_bf16 v[88:91], v[200:203], v[132:135], v[88:91]
    v_mfma_f32_16x16x32_bf16 v[92:95], v[204:207], v[136:139], v[92:95]
    v_mfma_f32_16x16x32_bf16 v[88:91], v[208:211], v[140:143], v[88:91]
    v_mfma_f32_16x16x32_bf16 v[92:95], v[212:215], v[144:147], v[92:95]
    v_mfma_f32_16x16x32_bf16 v[88:91], v[216:219], v[148:151], v[88:91]
    v_mfma_f32_16x16x32_bf16 v[92:95], v[220:223], v[152:155], v[92:95]
    v_mfma_f32_16x16x32_bf16 v[88:91], v[224:227], v[156:159], v[88:91]
    v_mfma_f32_16x16x32_bf16 v[92:95], v[228:231], v[160:163], v[92:95]
    v_lshrrev_b32 v74, 3, v1
    v_and_b32 v75, 7, v1
    v_lshlrev_b32 v75, 1, v75
    s_lshl_b32 s58, s38, 7
    s_add_u32 s58, s58, 1228800
    v_add_u32 v75, s58, v75
    v_add_u32 v76, 16, v75
    s_nop 4
    v_pk_add_f32 v[70:71], v[88:89], v[92:93]
    v_cvt_pk_bf16_f32 v70, v70, v71
    v_lshlrev_b32 v72, 16, v70
    v_and_b32 v73, s44, v70
    s_nop 0
    v_mov_b32_dpp v70, v72 row_ror:8 row_mask:0xf bank_mask:0xf
    v_mov_b32_dpp v71, v73 row_ror:8 row_mask:0xf bank_mask:0xf
    v_mul_f32 v78, 0xbfb8aa3b, v72
    v_mul_f32 v79, 0xbfb8aa3b, v73
    v_exp_f32 v78, v78
    v_exp_f32 v79, v79
    v_add_f32 v78, 1.0, v78
    v_add_f32 v79, 1.0, v79
    v_rcp_f32 v78, v78
    v_rcp_f32 v79, v79
    v_mul_f32 v78, v72, v78
    v_mul_f32 v79, v73, v79
    v_cvt_pk_bf16_f32 v78, v78, v79
    v_lshlrev_b32 v72, 16, v78
    v_and_b32 v73, s44, v78
    v_mul_f32 v72, v72, v70
    v_mul_f32 v73, v73, v71
    v_cvt_pk_bf16_f32 v72, v72, v73
    s_nop 1
    v_mov_b32_dpp v73, v72 quad_perm:[1,0,3,2] row_mask:0xf bank_mask:0xf
    s_mov_b32 s58, 0x05040100
    s_mov_b32 s59, 0x07060302
    v_perm_b32 v78, v73, v72, s58
    v_perm_b32 v79, v73, v72, s59
    v_min_u32 v78, -2, v78
    v_min_u32 v79, -2, v79
    s_mov_b64 exec, 0x55
    global_store_dword v75, v78, s[36:37] sc1
    global_store_dword v76, v79, s[36:37] sc1
    s_branch L_end
L_down:
    s_sub_u32 s73, s38, 192
    s_lshl_b32 s73, s73, 5
    v_and_b32 v49, 1, v245
    v_cmp_eq_u32 vcc, 1, v49
    v_mov_b32 v50, s74
    v_mov_b32 v51, s75
    v_cndmask_b32 v50, v50, v51, vcc
    v_and_b32 v51, 14, v1
    v_lshl_add_u32 v50, v51, 1, v50
    v_add_u32 v50, s73, v50
    v_lshlrev_b32 v47, 4, v244
    v_lshl_add_u32 v47, v245, 7, v47
    s_mul_i32 s58, s72, 5632
    s_add_u32 s58, s58, 1228800
    v_add_u32 v47, s58, v47
    s_cmp_eq_u32 s72, 3
    s_cselect_b32 s59, 512, 0
    v_subrev_u32 v48, s59, v47
    s_mov_b32 s47, 0
L_s3d_22:
    s_add_u32 s47, s47, 1
    s_cmp_gt_u32 s47, 40000
    s_cbranch_scc1 L_s3dx_23
    global_load_dword v80, v50, s[36:37] sc1
    global_load_dword v81, v50, s[36:37] offset:1024 sc1
    s_waitcnt vmcnt(0)
    v_max_u32 v49, v80, v81
    v_cmp_eq_u32 vcc, -1, v49
    s_cbranch_vccnz L_s3d_22
L_s3dx_23:
    v_and_b32 v49, 1, v245
    v_cmp_eq_u32 vcc, 1, v49
    v_mov_b32 v53, s70
    v_mov_b32 v54, s71
    v_cndmask_b32 v53, v53, v54, vcc
    v_mov_b32 v55, s76
    v_mov_b32 v56, s77
    v_cndmask_b32 v55, v55, v56, vcc
    v_lshrrev_b32 v53, 16, v53
    v_and_b32 v54, 0x7fff, v53
    v_xor_b32 v56, 0xffff, v53
    v_cmp_lt_u32 vcc, 0x7fff, v53
    s_nop 1
    v_cndmask_b32 v53, v56, v54, vcc
    v_lshlrev_b32 v53, 16, v53
    v_mul_f32 v53, 0xbfb8aa3b, v53
    v_exp_f32 v53, v53
    s_nop 0
    v_add_f32 v53, 1.0, v53
    v_rcp_f32 v53, v53
    s_nop 0
    v_cvt_pk_bf16_f32 v53, v53, v53
    v_and_b32 v82, s44, v53
    v_and_b32 v54, 1, v1
    v_cmp_eq_u32 vcc, 1, v54
    v_lshlrev_b32 v56, 16, v80
    v_and_b32 v57, s44, v80
    v_cndmask_b32 v83, v56, v57, vcc
    v_lshlrev_b32 v58, 16, v81
    v_and_b32 v57, s44, v81
    v_cndmask_b32 v84, v58, v57, vcc
    v_lshlrev_b32 v59, 2, v244
    s_lshl_b32 s58, s73, 1
    s_add_u32 s58, s58, 46336
    v_add_u32 v59, s58, v59
    ds_read_b32 v85, v59
    v_lshlrev_b32 v55, 10, v55
    v_lshl_add_u32 v55, v244, 1, v55
    v_add_u32 v86, s73, v55
    v_add_u32 v50, 4096, v47
    v_add_u32 v51, 4096, v48
    v_cmp_gt_u32 vcc, 2, v244
    s_nop 0
    s_and_saveexec_b64 s[48:49], vcc
    s_mov_b32 s47, 0
L_s4_24:
    s_add_u32 s47, s47, 1
    s_cmp_gt_u32 s47, 40000
    s_cbranch_scc1 L_s4x_25
    global_load_dwordx4 v[200:203], v47, s[36:37] offset:0 sc1
    global_load_dwordx4 v[204:207], v47, s[36:37] offset:512 sc1
    global_load_dwordx4 v[208:211], v47, s[36:37] offset:1024 sc1
    global_load_dwordx4 v[212:215], v47, s[36:37] offset:1536 sc1
    global_load_dwordx4 v[216:219], v47, s[36:37] offset:2048 sc1
    global_load_dwordx4 v[220:223], v47, s[36:37] offset:2560 sc1
    global_load_dwordx4 v[224:227], v47, s[36:37] offset:3072 sc1
    global_load_dwordx4 v[228:231], v47, s[36:37] offset:3584 sc1
    global_load_dwordx4 v[232:235], v50, s[36:37] offset:0 sc1
    global_load_dwordx4 v[236:239], v50, s[36:37] offset:512 sc1
    global_load_dwordx4 v[240:243], v51, s[36:37] offset:1024 sc1
    s_waitcnt vmcnt(0)
    v_max3_u32 v49, v200, v203, v204
    v_max3_u32 v49, v49, v207, v208
    v_max3_u32 v49, v49, v211, v212
    v_max3_u32 v49, v49, v215, v216
    v_max3_u32 v49, v49, v219, v220
    v_max3_u32 v49, v49, v223, v224
    v_max3_u32 v49, v49, v227, v228
    v_max3_u32 v49, v49, v231, v232
    v_max3_u32 v49, v49, v235, v236
    v_max3_u32 v49, v49, v239, v240
    v_max_u32 v49, v49, v243
    v_cmp_eq_u32 vcc, -1, v49
    s_cbranch_vccnz L_s4_24
L_s4x_25:
    s_mov_b64 exec, s[48:49]
    s_waitcnt lgkmcnt(0)
    v_mfma_f32_16x16x32_bf16 v[88:91], v[200:203], v[100:103], 0
    v_mfma_f32_16x16x32_bf16 v[92:95], v[204:207], v[104:107], 0
    v_mfma_f32_16x16x32_bf16 v[88:91], v[208:211], v[108:111], v[88:91]
    v_mfma_f32_16x16x32_bf16 v[92:95], v[212:215], v[112:115], v[92:95]
    v_mfma_f32_16x16x32_bf16 v[88:91], v[216:219], v[116:119], v[88:91]
    v_mfma_f32_16x16x32_bf16 v[92:95], v[220:223], v[120:123], v[92:95]
    v_mfma_f32_16x16x32_bf16 v[88:91], v[224:227], v[124:127], v[88:91]
    v_mfma_f32_16x16x32_bf16 v[92:95], v[228:231], v[128:131], v[92:95]
    v_mfma_f32_16x16x32_bf16 v[88:91], v[232:235], v[132:135], v[88:91]
    v_mfma_f32_16x16x32_bf16 v[92:95], v[236:239], v[136:139], v[92:95]
    v_mfma_f32_16x16x32_bf16 v[88:91], v[240:243], v[140:143], v[88:91]
    s_lshl_b32 s58, s72, 7
    s_add_u32 s58, s58, 88256
    v_lshlrev_b32 v48, 2, v1
    v_add_u32 v49, s58, v48
    v_and_b32 v48, 127, v48
    v_add_u32 v48, 88256, v48
    s_nop 4
    v_pk_add_f32 v[70:71], v[88:89], v[92:93]
    s_mov_b64 exec, 0xffff
    ds_write_b32 v49, v70
    ds_write_b32 v49, v71 offset:64
    s_mov_b64 exec, -1
    s_waitcnt lgkmcnt(0)
    s_barrier
    s_cmp_eq_u32 s72, 0
    s_cbranch_scc0 L_end
    ds_read_b32 v52, v48
    ds_read_b32 v53, v48 offset:128
    ds_read_b32 v54, v48 offset:256
    ds_read_b32 v55, v48 offset:384
    s_waitcnt lgkmcnt(0)
    v_add_f32 v52, v52, v53
    v_add_f32 v54, v54, v55
    v_add_f32 v52, v52, v54
    v_cvt_pk_bf16_f32 v52, v52, v52
    v_and_b32 v52, s44, v52
    v_mul_f32 v52, v52, v82
    v_cvt_pk_bf16_f32 v52, v52, v52
    v_and_b32 v52, s44, v52
    v_add_f32 v52, v83, v52
    v_cvt_pk_bf16_f32 v52, v52, v52
    v_and_b32 v52, s44, v52
    v_mul_f32 v52, v85, v52
    v_cvt_pk_bf16_f32 v52, v52, v52
    v_and_b32 v52, s44, v52
    v_add_f32 v52, v84, v52
    v_cvt_pk_bf16_f32 v52, v52, v52
    s_mov_b32 exec_lo, -1
    s_mov_b32 exec_hi, 0
    global_store_short v86, v52, s[32:33]
L_end:
    s_endpgm
L_exit:
    s_endpgm
.section .rodata,"a"
.p2align 6
.amdhsa_kernel adaLN_cond__ssm_conv_s4d__moe_arch_mod__prompt_kernel
  .amdhsa_next_free_vgpr 256
  .amdhsa_next_free_sgpr 96
  .amdhsa_accum_offset 256
  .amdhsa_group_segment_fixed_size 0
  .amdhsa_kernarg_size 136
  .amdhsa_user_sgpr_count 2
  .amdhsa_user_sgpr_kernarg_segment_ptr 1
  .amdhsa_system_sgpr_workgroup_id_x 1
.end_amdhsa_kernel
```
